```python
import torch

def _softmax(x, axis=-1):
    return torch.softmax(x, dim=axis)
def _gelu(x):
    return torch.nn.functional.gelu(x, approximate="tanh")
def _silu(x):
    return torch.nn.functional.silu(x)
def _sigmoid(x):
    return torch.sigmoid(x)
def _layernorm(x, axis=-1, eps=1e-5):
    m = x.mean(dim=axis, keepdim=True)
    v = x.var(dim=axis, keepdim=True, unbiased=False)
    return (x - m) / torch.sqrt(v + eps)
def _scatter_add(tgt, idx, src, axis=0):
    return tgt.clone().index_add_(axis, idx, src)
def _segment_sum(src, seg, n):
    out = torch.zeros((n,) + src.shape[1:], dtype=src.dtype)
    return out.index_add_(0, seg, src)
def _pad(x, pw):
    flat = tuple(v for pair in reversed(pw) for v in pair)
    return torch.nn.functional.pad(x, flat)

kernel_name = 'sequential_preLN__mha_block__dense_activation_mish__prompt'

def setup_inputs():

    _w = (lambda a: (lambda t: t.to(torch.bfloat16) if t.is_floating_point() else t)(torch.as_tensor(a)))
    def _A_setup():
        B, S, D, H = 1, 2048, 512, 32
        return {
            "x": _w((lambda *s: torch.randn(*s, dtype=torch.bfloat16) * 0.05)(B, S, D)),
            "wqkv": _w((lambda *s: torch.randn(*s, dtype=torch.bfloat16) * 0.05)(D, 3 * D)),
            "wo": _w((lambda *s: torch.randn(*s, dtype=torch.bfloat16) * 0.05)(D, D)),
        }
    _A_in = _A_setup()

    def _B_setup():
        B, S, D, F = 1, 2048, 512, 1376
        return {
            "x": _w((lambda *s: torch.randn(*s, dtype=torch.bfloat16) * 0.05)(B, S, D)),
            "w1": _w((lambda *s: torch.randn(*s, dtype=torch.bfloat16) * 0.8)(D, F) * (D ** -0.5)),
            "b1": _w((lambda *s: torch.randn(*s, dtype=torch.bfloat16) * 0.8)(F)),
            "w2": _w((lambda *s: torch.randn(*s, dtype=torch.bfloat16) * 0.2)(F, D) * (F ** -0.5)),
        }
    _B_in = _B_setup()

    return {
        "A_x": _A_in["x"],
        "A_wqkv": _A_in["wqkv"],
        "A_wo": _A_in["wo"],
        "B_x": _B_in["x"],
        "B_w1": _B_in["w1"],
        "B_b1": _B_in["b1"],
        "B_w2": _B_in["w2"],
    }

def reference(A_x, A_wqkv, A_wo, B_x, B_w1, B_b1, B_w2):
    def _A_ref(x, wqkv, wo):
        B, S, D = x.shape
        H = 32
        Dh = D // H
        qkv = (lambda x, *d: x.permute(*d))((x @ wqkv).reshape(B, S, 3, H, Dh), 2, 0, 3, 1, 4)
        q, k, v = qkv[0], qkv[1], qkv[2]
        scores = torch.einsum("bhqd,bhkd->bhqk", q, k) * (Dh ** -0.5)
        p = _softmax(scores, axis=-1)
        o = torch.einsum("bhqk,bhkd->bhqd", p, v)
        return (lambda x, *d: x.permute(*d))(o, 0, 2, 1, 3).reshape(B, S, D) @ wo

    def _B_ref(x, w1, b1, w2):
        h = torch.einsum("bsd,df->bsf", x, w1) + b1
        sp = torch.log1p(torch.exp(-torch.abs(h))) + torch.where(h > 0, h, torch.zeros_like(h))
        act = h * torch.tanh(sp)
        return torch.einsum("bsf,fd->bsd", act, w2)

    x = A_x
    h = x + _A_ref(_layernorm(x, axis=-1), A_wqkv, A_wo)
    h2 = h + _B_ref(_layernorm(h, axis=-1), B_w1, B_b1, B_w2)
    return h2
```

```asm
; @launch kernel=k1_kernel grid=(256,1,1) block=(768,1,1) lds=163840
; @launch kernel=k2_kernel grid=(256,1,1) block=(1024,1,1) lds=139520
; @launch kernel=k3_kernel grid=(768,1,1) block=(768,1,1) lds=163840
.amdgcn_target "amdgcn-amd-amdhsa--gfx950"
.text
.globl k1_kernel
.p2align 8
.type k1_kernel,@function
k1_kernel:
    s_cmp_ge_u32 s2, 256
    s_cbranch_scc1 k1_kernel_exit
    s_load_dwordx4 s[20:23], s[0:1], 0
    s_load_dwordx2 s[24:25], s[0:1], 72
    v_lshrrev_b32 v1, 6, v0
    v_and_b32 v0, 63, v0
    s_nop 0
    v_readfirstlane_b32 s47, v1
    s_and_b32 s26, s47, 3
    s_and_b32 s27, s2, 7
    s_lshr_b32 s28, s2, 3
    s_and_b32 s29, s27, 3
    s_lshl_b32 s29, s29, 2
    s_and_b32 s30, s28, 3
    s_add_u32 s29, s29, s30
    s_lshr_b32 s30, s27, 2
    s_lshl_b32 s30, s30, 3
    s_lshr_b32 s31, s28, 2
    s_add_u32 s30, s30, s31
    s_lshl_b32 s31, s29, 2
    s_add_u32 s31, s31, s26
    v_lshrrev_b32 v30, 5, v0
    v_and_b32 v31, 31, v0
    s_lshl_b32 s32, s26, 12
    s_add_u32 s32, s32, 12288
    v_bfe_u32 v19, v31, 1, 3
    v_lshlrev_b32 v20, 7, v31
    v_add_u32 v20, s32, v20
    v_add_u32 v21, 0, v30
    v_xor_b32 v21, v21, v19
    v_lshl_add_u32 v6, v21, 4, v20
    v_add_u32 v21, 2, v30
    v_xor_b32 v21, v21, v19
    v_lshl_add_u32 v7, v21, 4, v20
    v_add_u32 v21, 4, v30
    v_xor_b32 v21, v21, v19
    v_lshl_add_u32 v8, v21, 4, v20
    v_add_u32 v21, 6, v30
    v_xor_b32 v21, v21, v19
    v_lshl_add_u32 v9, v21, 4, v20
    v_mul_u32_u24 v19, 8, v30
    v_bfe_u32 v20, v0, 2, 2
    v_add_u32 v19, v19, v20
    v_mul_u32_u24 v19, 192, v19
    v_bfe_u32 v20, v0, 4, 1
    v_lshl_add_u32 v19, v20, 5, v19
    v_and_b32 v20, 3, v0
    v_lshl_add_u32 v10, v20, 3, v19
    v_lshlrev_b32 v4, 4, v0
    s_cmp_ge_u32 s47, 4
    s_cbranch_scc1 k1_kernel_loader
    v_mov_b32 v64, 0
    v_mov_b32 v65, 0
    v_mov_b32 v66, 0
    v_mov_b32 v67, 0
    v_mov_b32 v68, 0
    v_mov_b32 v69, 0
    v_mov_b32 v70, 0
    v_mov_b32 v71, 0
    v_mov_b32 v72, 0
    v_mov_b32 v73, 0
    v_mov_b32 v74, 0
    v_mov_b32 v75, 0
    v_mov_b32 v76, 0
    v_mov_b32 v77, 0
    v_mov_b32 v78, 0
    v_mov_b32 v79, 0
    v_mov_b32 v80, 0
    v_mov_b32 v81, 0
    v_mov_b32 v82, 0
    v_mov_b32 v83, 0
    v_mov_b32 v84, 0
    v_mov_b32 v85, 0
    v_mov_b32 v86, 0
    v_mov_b32 v87, 0
    v_mov_b32 v88, 0
    v_mov_b32 v89, 0
    v_mov_b32 v90, 0
    v_mov_b32 v91, 0
    v_mov_b32 v92, 0
    v_mov_b32 v93, 0
    v_mov_b32 v94, 0
    v_mov_b32 v95, 0
    v_mov_b32 v96, 0
    v_mov_b32 v97, 0
    v_mov_b32 v98, 0
    v_mov_b32 v99, 0
    v_mov_b32 v100, 0
    v_mov_b32 v101, 0
    v_mov_b32 v102, 0
    v_mov_b32 v103, 0
    v_mov_b32 v104, 0
    v_mov_b32 v105, 0
    v_mov_b32 v106, 0
    v_mov_b32 v107, 0
    v_mov_b32 v108, 0
    v_mov_b32 v109, 0
    v_mov_b32 v110, 0
    v_mov_b32 v111, 0
    s_waitcnt lgkmcnt(0)
    s_mov_b32 s12, s24
    s_mov_b32 s13, s25
    s_mov_b32 s14, 33554432
    s_mov_b32 s15, 0x00020000
    s_cmp_lg_u32 s2, 0
    s_cbranch_scc1 k1_kernel_1
    s_cmp_lg_u32 s47, 0
    s_cbranch_scc1 k1_kernel_1
    v_lshlrev_b32 v19, 8, v0
    v_mov_b32 v20, 0
    s_mov_b32 s33, 17235968
    buffer_store_dword v20, v19, s[12:15], s33 offen
    s_add_u32 s33, s33, 16384
    buffer_store_dword v20, v19, s[12:15], s33 offen
k1_kernel_1:
    s_barrier
    ds_read_b128 v[112:115], v6
    ds_read_b64_tr_b16 v[40:41], v10 offset:0
    ds_read_b64_tr_b16 v[42:43], v10 offset:768
    ds_read_b64_tr_b16 v[44:45], v10 offset:64
    ds_read_b64_tr_b16 v[46:47], v10 offset:832
    ds_read_b64_tr_b16 v[48:49], v10 offset:128
    ds_read_b64_tr_b16 v[50:51], v10 offset:896
    s_mov_b32 s48, 0
k1_kernel_2:
    ds_read_b128 v[116:119], v7
    ds_read_b64_tr_b16 v[52:53], v10 offset:3072
    ds_read_b64_tr_b16 v[54:55], v10 offset:3840
    ds_read_b64_tr_b16 v[56:57], v10 offset:3136
    ds_read_b64_tr_b16 v[58:59], v10 offset:3904
    ds_read_b64_tr_b16 v[60:61], v10 offset:3200
    ds_read_b64_tr_b16 v[62:63], v10 offset:3968
    s_waitcnt lgkmcnt(7)
    v_mfma_f32_32x32x16_bf16 v[64:79], v[40:43], v[112:115], v[64:79]
    v_mfma_f32_32x32x16_bf16 v[80:95], v[44:47], v[112:115], v[80:95]
    v_mfma_f32_32x32x16_bf16 v[96:111], v[48:51], v[112:115], v[96:111]
    ds_read_b128 v[112:115], v8
    ds_read_b64_tr_b16 v[40:41], v10 offset:6144
    ds_read_b64_tr_b16 v[42:43], v10 offset:6912
    ds_read_b64_tr_b16 v[44:45], v10 offset:6208
    ds_read_b64_tr_b16 v[46:47], v10 offset:6976
    ds_read_b64_tr_b16 v[48:49], v10 offset:6272
    ds_read_b64_tr_b16 v[50:51], v10 offset:7040
    s_waitcnt lgkmcnt(7)
    v_mfma_f32_32x32x16_bf16 v[64:79], v[52:55], v[116:119], v[64:79]
    v_mfma_f32_32x32x16_bf16 v[80:95], v[56:59], v[116:119], v[80:95]
    v_mfma_f32_32x32x16_bf16 v[96:111], v[60:63], v[116:119], v[96:111]
    ds_read_b128 v[116:119], v9
    ds_read_b64_tr_b16 v[52:53], v10 offset:9216
    ds_read_b64_tr_b16 v[54:55], v10 offset:9984
    ds_read_b64_tr_b16 v[56:57], v10 offset:9280
    ds_read_b64_tr_b16 v[58:59], v10 offset:10048
    ds_read_b64_tr_b16 v[60:61], v10 offset:9344
    ds_read_b64_tr_b16 v[62:63], v10 offset:10112
    s_waitcnt lgkmcnt(7)
    v_mfma_f32_32x32x16_bf16 v[64:79], v[40:43], v[112:115], v[64:79]
    v_mfma_f32_32x32x16_bf16 v[80:95], v[44:47], v[112:115], v[80:95]
    v_mfma_f32_32x32x16_bf16 v[96:111], v[48:51], v[112:115], v[96:111]
    s_mov_b32 s49, 28672
    s_cmp_eq_u32 s48, 4
    s_cselect_b32 s49, 0xfffe4000, s49
    s_cmp_eq_u32 s48, 7
    s_waitcnt lgkmcnt(0)
    s_cbranch_scc1 k1_kernel_3
    s_barrier
    v_add_u32 v6, s49, v6
    v_add_u32 v7, s49, v7
    v_add_u32 v8, s49, v8
    v_add_u32 v9, s49, v9
    v_add_u32 v10, s49, v10
    ds_read_b128 v[112:115], v6
    ds_read_b64_tr_b16 v[40:41], v10 offset:0
    ds_read_b64_tr_b16 v[42:43], v10 offset:768
    ds_read_b64_tr_b16 v[44:45], v10 offset:64
    ds_read_b64_tr_b16 v[46:47], v10 offset:832
    ds_read_b64_tr_b16 v[48:49], v10 offset:128
    ds_read_b64_tr_b16 v[50:51], v10 offset:896
    v_mfma_f32_32x32x16_bf16 v[64:79], v[52:55], v[116:119], v[64:79]
    v_mfma_f32_32x32x16_bf16 v[80:95], v[56:59], v[116:119], v[80:95]
    v_mfma_f32_32x32x16_bf16 v[96:111], v[60:63], v[116:119], v[96:111]
    s_add_u32 s48, s48, 1
    s_branch k1_kernel_2
k1_kernel_3:
    v_mfma_f32_32x32x16_bf16 v[64:79], v[52:55], v[116:119], v[64:79]
    v_mfma_f32_32x32x16_bf16 v[80:95], v[56:59], v[116:119], v[80:95]
    v_mfma_f32_32x32x16_bf16 v[96:111], v[60:63], v[116:119], v[96:111]
    s_waitcnt vmcnt(0)
    s_barrier
    v_lshlrev_b32 v19, 2, v0
    v_add_u32 v19, 143360, v19
    v_lshlrev_b32 v20, 2, v31
    v_add_u32 v20, 143616, v20
    ds_read_b32 v112, v19 offset:0
    ds_read_b32 v120, v20 offset:0
    ds_read_b32 v113, v19 offset:384
    ds_read_b32 v121, v20 offset:384
    ds_read_b32 v114, v19 offset:768
    ds_read_b32 v122, v20 offset:768
    ds_read_b32 v115, v19 offset:1152
    ds_read_b32 v123, v20 offset:1152
    ds_read_b32 v116, v19 offset:1536
    ds_read_b32 v124, v20 offset:1536
    ds_read_b32 v117, v19 offset:1920
    ds_read_b32 v125, v20 offset:1920
    ds_read_b32 v118, v19 offset:2304
    ds_read_b32 v126, v20 offset:2304
    ds_read_b32 v119, v19 offset:2688
    ds_read_b32 v127, v20 offset:2688
    s_lshl_b32 s33, s26, 8
    s_add_u32 s33, s33, 146432
    v_lshlrev_b32 v21, 2, v31
    v_add_u32 v21, s33, v21
    s_waitcnt lgkmcnt(0)
    ds_read_b32 v12, v21
    ds_read_b32 v14, v21 offset:128
    v_add_f32 v112, v112, v113
    v_add_f32 v120, v120, v121
    v_add_f32 v112, v112, v114
    v_add_f32 v120, v120, v122
    v_add_f32 v112, v112, v115
    v_add_f32 v120, v120, v123
    v_add_f32 v112, v112, v116
    v_add_f32 v120, v120, v124
    v_add_f32 v112, v112, v117
    v_add_f32 v120, v120, v125
    v_add_f32 v112, v112, v118
    v_add_f32 v120, v120, v126
    v_add_f32 v112, v112, v119
    v_add_f32 v120, v120, v127
    s_waitcnt lgkmcnt(0)
    v_mul_f32 v12, 0x3b000000, v12
    v_mul_f32 v14, 0x3b000000, v14
    v_fma_f32 v14, -v12, v12, v14
    v_max_f32 v14, 0, v14
    v_add_f32 v14, 0x3727c5ac, v14
    v_rsq_f32 v13, v14
    s_nop 0
    v_mul_f32 v12, v12, v13
    v_sub_f32 v12, 0, v12
    s_lshl_b32 s32, s26, 10
    s_add_u32 s32, s32, 147456
    v_lshlrev_b32 v19, 2, v0
    v_add_u32 v19, s32, v19
    v_lshlrev_b32 v20, 2, v31
    v_add_u32 v20, s32, v20
    ds_write_b32 v19, v112
    ds_write_b32 v20, v120 offset:256
    v_lshlrev_b32 v19, 4, v30
    v_add_u32 v19, s32, v19
    s_waitcnt lgkmcnt(0)
    ds_read_b128 v[112:115], v19 offset:0
    ds_read_b128 v[116:119], v19 offset:32
    ds_read_b128 v[120:123], v19 offset:64
    ds_read_b128 v[124:127], v19 offset:96
    ds_read_b128 v[128:131], v19 offset:128
    ds_read_b128 v[132:135], v19 offset:160
    ds_read_b128 v[136:139], v19 offset:192
    ds_read_b128 v[140:143], v19 offset:224
    ds_read_b128 v[144:147], v19 offset:256
    ds_read_b128 v[148:151], v19 offset:288
    ds_read_b128 v[152:155], v19 offset:320
    ds_read_b128 v[156:159], v19 offset:352
    v_lshlrev_b32 v24, 4, v0
    v_lshlrev_b32 v25, 5, v31
    v_lshl_add_u32 v25, v30, 4, v25
    s_lshl_b32 s38, s31, 10
    s_waitcnt lgkmcnt(0)
    s_mul_i32 s39, s30, 3
    s_add_u32 s39, s39, 0
    s_lshr_b32 s40, s39, 4
    s_and_b32 s41, s39, 15
    s_lshl_b32 s42, s40, 21
    s_lshl_b32 s41, s41, 17
    s_add_u32 s42, s42, s41
    s_add_u32 s42, s42, s38
    s_add_u32 s43, s42, 65536
    s_cmp_eq_u32 s40, 2
    s_cselect_b64 s[44:45], -1, 0
    s_cmp_eq_u32 s40, 0
    s_cselect_b32 s46, 0x3eb8aa3b, 1.0
    v_cndmask_b32 v26, v24, v25, s[44:45]
    v_mul_f32 v20, s46, v13
    v_mul_f32 v22, s46, v12
    v_pk_mul_f32 v[112:113], v[112:113], v[22:23] op_sel_hi:[1,0]
    v_pk_mul_f32 v[114:115], v[114:115], v[22:23] op_sel_hi:[1,0]
    v_pk_mul_f32 v[116:117], v[116:117], v[22:23] op_sel_hi:[1,0]
    v_pk_mul_f32 v[118:119], v[118:119], v[22:23] op_sel_hi:[1,0]
    v_pk_mul_f32 v[120:121], v[120:121], v[22:23] op_sel_hi:[1,0]
    v_pk_mul_f32 v[122:123], v[122:123], v[22:23] op_sel_hi:[1,0]
    v_pk_mul_f32 v[124:125], v[124:125], v[22:23] op_sel_hi:[1,0]
    v_pk_mul_f32 v[126:127], v[126:127], v[22:23] op_sel_hi:[1,0]
    v_pk_fma_f32 v[64:65], v[64:65], v[20:21], v[112:113] op_sel_hi:[1,0,1]
    v_pk_fma_f32 v[66:67], v[66:67], v[20:21], v[114:115] op_sel_hi:[1,0,1]
    v_pk_fma_f32 v[68:69], v[68:69], v[20:21], v[116:117] op_sel_hi:[1,0,1]
    v_pk_fma_f32 v[70:71], v[70:71], v[20:21], v[118:119] op_sel_hi:[1,0,1]
    v_pk_fma_f32 v[72:73], v[72:73], v[20:21], v[120:121] op_sel_hi:[1,0,1]
    v_pk_fma_f32 v[74:75], v[74:75], v[20:21], v[122:123] op_sel_hi:[1,0,1]
    v_pk_fma_f32 v[76:77], v[76:77], v[20:21], v[124:125] op_sel_hi:[1,0,1]
    v_pk_fma_f32 v[78:79], v[78:79], v[20:21], v[126:127] op_sel_hi:[1,0,1]
    v_cvt_pk_bf16_f32 v40, v64, v65
    v_cvt_pk_bf16_f32 v41, v66, v67
    v_cvt_pk_bf16_f32 v42, v68, v69
    v_cvt_pk_bf16_f32 v43, v70, v71
    v_cvt_pk_bf16_f32 v44, v72, v73
    v_cvt_pk_bf16_f32 v45, v74, v75
    v_cvt_pk_bf16_f32 v46, v76, v77
    v_cvt_pk_bf16_f32 v47, v78, v79
    buffer_store_dwordx4 v[40:43], v26, s[12:15], s42 offen sc1
    buffer_store_dwordx4 v[44:47], v26, s[12:15], s43 offen sc1
    s_mul_i32 s39, s30, 3
    s_add_u32 s39, s39, 1
    s_lshr_b32 s40, s39, 4
    s_and_b32 s41, s39, 15
    s_lshl_b32 s42, s40, 21
    s_lshl_b32 s41, s41, 17
    s_add_u32 s42, s42, s41
    s_add_u32 s42, s42, s38
    s_add_u32 s43, s42, 65536
    s_cmp_eq_u32 s40, 2
    s_cselect_b64 s[44:45], -1, 0
    s_cmp_eq_u32 s40, 0
    s_cselect_b32 s46, 0x3eb8aa3b, 1.0
    v_cndmask_b32 v26, v24, v25, s[44:45]
    v_mul_f32 v20, s46, v13
    v_mul_f32 v22, s46, v12
    v_pk_mul_f32 v[128:129], v[128:129], v[22:23] op_sel_hi:[1,0]
    v_pk_mul_f32 v[130:131], v[130:131], v[22:23] op_sel_hi:[1,0]
    v_pk_mul_f32 v[132:133], v[132:133], v[22:23] op_sel_hi:[1,0]
    v_pk_mul_f32 v[134:135], v[134:135], v[22:23] op_sel_hi:[1,0]
    v_pk_mul_f32 v[136:137], v[136:137], v[22:23] op_sel_hi:[1,0]
    v_pk_mul_f32 v[138:139], v[138:139], v[22:23] op_sel_hi:[1,0]
    v_pk_mul_f32 v[140:141], v[140:141], v[22:23] op_sel_hi:[1,0]
    v_pk_mul_f32 v[142:143], v[142:143], v[22:23] op_sel_hi:[1,0]
    v_pk_fma_f32 v[80:81], v[80:81], v[20:21], v[128:129] op_sel_hi:[1,0,1]
    v_pk_fma_f32 v[82:83], v[82:83], v[20:21], v[130:131] op_sel_hi:[1,0,1]
    v_pk_fma_f32 v[84:85], v[84:85], v[20:21], v[132:133] op_sel_hi:[1,0,1]
    v_pk_fma_f32 v[86:87], v[86:87], v[20:21], v[134:135] op_sel_hi:[1,0,1]
    v_pk_fma_f32 v[88:89], v[88:89], v[20:21], v[136:137] op_sel_hi:[1,0,1]
    v_pk_fma_f32 v[90:91], v[90:91], v[20:21], v[138:139] op_sel_hi:[1,0,1]
    v_pk_fma_f32 v[92:93], v[92:93], v[20:21], v[140:141] op_sel_hi:[1,0,1]
    v_pk_fma_f32 v[94:95], v[94:95], v[20:21], v[142:143] op_sel_hi:[1,0,1]
    v_cvt_pk_bf16_f32 v48, v80, v81
    v_cvt_pk_bf16_f32 v49, v82, v83
    v_cvt_pk_bf16_f32 v50, v84, v85
    v_cvt_pk_bf16_f32 v51, v86, v87
    v_cvt_pk_bf16_f32 v52, v88, v89
    v_cvt_pk_bf16_f32 v53, v90, v91
    v_cvt_pk_bf16_f32 v54, v92, v93
    v_cvt_pk_bf16_f32 v55, v94, v95
    buffer_store_dwordx4 v[48:51], v26, s[12:15], s42 offen sc1
    buffer_store_dwordx4 v[52:55], v26, s[12:15], s43 offen sc1
    s_mul_i32 s39, s30, 3
    s_add_u32 s39, s39, 2
    s_lshr_b32 s40, s39, 4
    s_and_b32 s41, s39, 15
    s_lshl_b32 s42, s40, 21
    s_lshl_b32 s41, s41, 17
    s_add_u32 s42, s42, s41
    s_add_u32 s42, s42, s38
    s_add_u32 s43, s42, 65536
    s_cmp_eq_u32 s40, 2
    s_cselect_b64 s[44:45], -1, 0
    s_cmp_eq_u32 s40, 0
    s_cselect_b32 s46, 0x3eb8aa3b, 1.0
    v_cndmask_b32 v26, v24, v25, s[44:45]
    v_mul_f32 v20, s46, v13
    v_mul_f32 v22, s46, v12
    v_pk_mul_f32 v[144:145], v[144:145], v[22:23] op_sel_hi:[1,0]
    v_pk_mul_f32 v[146:147], v[146:147], v[22:23] op_sel_hi:[1,0]
    v_pk_mul_f32 v[148:149], v[148:149], v[22:23] op_sel_hi:[1,0]
    v_pk_mul_f32 v[150:151], v[150:151], v[22:23] op_sel_hi:[1,0]
    v_pk_mul_f32 v[152:153], v[152:153], v[22:23] op_sel_hi:[1,0]
    v_pk_mul_f32 v[154:155], v[154:155], v[22:23] op_sel_hi:[1,0]
    v_pk_mul_f32 v[156:157], v[156:157], v[22:23] op_sel_hi:[1,0]
    v_pk_mul_f32 v[158:159], v[158:159], v[22:23] op_sel_hi:[1,0]
    v_pk_fma_f32 v[96:97], v[96:97], v[20:21], v[144:145] op_sel_hi:[1,0,1]
    v_pk_fma_f32 v[98:99], v[98:99], v[20:21], v[146:147] op_sel_hi:[1,0,1]
    v_pk_fma_f32 v[100:101], v[100:101], v[20:21], v[148:149] op_sel_hi:[1,0,1]
    v_pk_fma_f32 v[102:103], v[102:103], v[20:21], v[150:151] op_sel_hi:[1,0,1]
    v_pk_fma_f32 v[104:105], v[104:105], v[20:21], v[152:153] op_sel_hi:[1,0,1]
    v_pk_fma_f32 v[106:107], v[106:107], v[20:21], v[154:155] op_sel_hi:[1,0,1]
    v_pk_fma_f32 v[108:109], v[108:109], v[20:21], v[156:157] op_sel_hi:[1,0,1]
    v_pk_fma_f32 v[110:111], v[110:111], v[20:21], v[158:159] op_sel_hi:[1,0,1]
    v_cvt_pk_bf16_f32 v56, v96, v97
    v_cvt_pk_bf16_f32 v57, v98, v99
    v_cvt_pk_bf16_f32 v58, v100, v101
    v_cvt_pk_bf16_f32 v59, v102, v103
    v_cvt_pk_bf16_f32 v60, v104, v105
    v_cvt_pk_bf16_f32 v61, v106, v107
    v_cvt_pk_bf16_f32 v62, v108, v109
    v_cvt_pk_bf16_f32 v63, v110, v111
    buffer_store_dwordx4 v[56:59], v26, s[12:15], s42 offen sc1
    buffer_store_dwordx4 v[60:63], v26, s[12:15], s43 offen sc1
    s_branch k1_kernel_exit
k1_kernel_loader:
    s_waitcnt lgkmcnt(0)
    s_cmp_ge_u32 s47, 8
    s_cbranch_scc1 k1_kernel_xloader
    v_add_u32 v19, 0, v0
    v_mul_u32_u24 v20, 171, v19
    v_lshrrev_b32 v20, 11, v20
    v_mul_u32_u24 v21, 12, v20
    v_sub_u32 v21, v19, v21
    v_lshlrev_b32 v21, 4, v21
    v_mul_u32_u24 v20, 3072, v20
    v_add_u32 v1, v20, v21
    v_add_u32 v19, 64, v0
    v_mul_u32_u24 v20, 171, v19
    v_lshrrev_b32 v20, 11, v20
    v_mul_u32_u24 v21, 12, v20
    v_sub_u32 v21, v19, v21
    v_lshlrev_b32 v21, 4, v21
    v_mul_u32_u24 v20, 3072, v20
    v_add_u32 v2, v20, v21
    v_add_u32 v19, 128, v0
    v_mul_u32_u24 v20, 171, v19
    v_lshrrev_b32 v20, 11, v20
    v_mul_u32_u24 v21, 12, v20
    v_sub_u32 v21, v19, v21
    v_lshlrev_b32 v21, 4, v21
    v_mul_u32_u24 v20, 3072, v20
    v_add_u32 v3, v20, v21
    s_mov_b32 s4, s22
    s_mov_b32 s5, s23
    s_mov_b32 s6, 1572864
    s_mov_b32 s7, 0x00020000
    s_mul_i32 s34, s26, 49152
    s_mul_i32 s36, s30, 192
    s_add_u32 s34, s34, s36
    s_mul_i32 s35, s26, 3072
    s_add_u32 m0, s35, 0
    s_add_u32 s37, s34, 0
    buffer_load_dwordx4 v1, s[4:7], s37 offen lds
    s_add_u32 m0, s35, 1024
    s_add_u32 s37, s34, 0
    buffer_load_dwordx4 v2, s[4:7], s37 offen lds
    s_add_u32 m0, s35, 2048
    s_add_u32 s37, s34, 0
    buffer_load_dwordx4 v3, s[4:7], s37 offen lds
    s_add_u32 m0, s35, 28672
    s_add_u32 s37, s34, 196608
    buffer_load_dwordx4 v1, s[4:7], s37 offen lds
    s_add_u32 m0, s35, 29696
    s_add_u32 s37, s34, 196608
    buffer_load_dwordx4 v2, s[4:7], s37 offen lds
    s_add_u32 m0, s35, 30720
    s_add_u32 s37, s34, 196608
    buffer_load_dwordx4 v3, s[4:7], s37 offen lds
    v_mov_b32 v12, 0
    v_mov_b32 v13, 0
    v_mov_b32 v14, 0
    v_mov_b32 v15, 0
    v_mov_b32 v16, 0
    v_mov_b32 v17, 0
    v_mov_b32 v18, 0
    s_mov_b32 s33, 0x3f803f80
    v_add_u32 v10, s35, v10
    s_waitcnt vmcnt(3)
    s_barrier
    s_add_u32 m0, s35, 57344
    s_add_u32 s37, s34, 393216
    buffer_load_dwordx4 v1, s[4:7], s37 offen lds
    s_add_u32 m0, s35, 58368
    s_add_u32 s37, s34, 393216
    buffer_load_dwordx4 v2, s[4:7], s37 offen lds
    s_add_u32 m0, s35, 59392
    s_add_u32 s37, s34, 393216
    buffer_load_dwordx4 v3, s[4:7], s37 offen lds
    s_add_u32 m0, s35, 86016
    s_add_u32 s37, s34, 589824
    buffer_load_dwordx4 v1, s[4:7], s37 offen lds
    s_add_u32 m0, s35, 87040
    s_add_u32 s37, s34, 589824
    buffer_load_dwordx4 v2, s[4:7], s37 offen lds
    s_add_u32 m0, s35, 88064
    s_add_u32 s37, s34, 589824
    buffer_load_dwordx4 v3, s[4:7], s37 offen lds
    ds_read_b64_tr_b16 v[80:81], v10 offset:0
    ds_read_b64_tr_b16 v[82:83], v10 offset:768
    ds_read_b64_tr_b16 v[84:85], v10 offset:64
    ds_read_b64_tr_b16 v[86:87], v10 offset:832
    ds_read_b64_tr_b16 v[88:89], v10 offset:128
    ds_read_b64_tr_b16 v[90:91], v10 offset:896
    ds_read_b128 v[64:67], v6
    ds_read_b128 v[68:71], v7
    ds_read_b128 v[72:75], v8
    ds_read_b128 v[76:79], v9
    s_waitcnt lgkmcnt(4)
    v_dot2c_f32_bf16 v16, s33, v80
    v_dot2c_f32_bf16 v17, s33, v84
    v_dot2c_f32_bf16 v18, s33, v88
    v_dot2c_f32_bf16 v16, s33, v81
    v_dot2c_f32_bf16 v17, s33, v85
    v_dot2c_f32_bf16 v18, s33, v89
    v_dot2c_f32_bf16 v16, s33, v82
    v_dot2c_f32_bf16 v17, s33, v86
    v_dot2c_f32_bf16 v18, s33, v90
    v_dot2c_f32_bf16 v16, s33, v83
    v_dot2c_f32_bf16 v17, s33, v87
    v_dot2c_f32_bf16 v18, s33, v91
    s_waitcnt lgkmcnt(0)
    v_dot2c_f32_bf16 v12, s33, v64
    v_dot2c_f32_bf16 v13, s33, v65
    v_dot2c_f32_bf16 v12, s33, v66
    v_dot2c_f32_bf16 v13, s33, v67
    v_dot2c_f32_bf16 v12, s33, v68
    v_dot2c_f32_bf16 v13, s33, v69
    v_dot2c_f32_bf16 v12, s33, v70
    v_dot2c_f32_bf16 v13, s33, v71
    v_dot2c_f32_bf16 v12, s33, v72
    v_dot2c_f32_bf16 v13, s33, v73
    v_dot2c_f32_bf16 v12, s33, v74
    v_dot2c_f32_bf16 v13, s33, v75
    v_dot2c_f32_bf16 v12, s33, v76
    v_dot2c_f32_bf16 v13, s33, v77
    v_dot2c_f32_bf16 v12, s33, v78
    v_dot2c_f32_bf16 v13, s33, v79
    s_waitcnt vmcnt(6)
    s_barrier
    s_add_u32 m0, s35, 114688
    s_add_u32 s37, s34, 786432
    buffer_load_dwordx4 v1, s[4:7], s37 offen lds
    s_add_u32 m0, s35, 115712
    s_add_u32 s37, s34, 786432
    buffer_load_dwordx4 v2, s[4:7], s37 offen lds
    s_add_u32 m0, s35, 116736
    s_add_u32 s37, s34, 786432
    buffer_load_dwordx4 v3, s[4:7], s37 offen lds
    s_add_u32 m0, s35, 0
    s_add_u32 s37, s34, 983040
    buffer_load_dwordx4 v1, s[4:7], s37 offen lds
    s_add_u32 m0, s35, 1024
    s_add_u32 s37, s34, 983040
    buffer_load_dwordx4 v2, s[4:7], s37 offen lds
    s_add_u32 m0, s35, 2048
    s_add_u32 s37, s34, 983040
    buffer_load_dwordx4 v3, s[4:7], s37 offen lds
    v_add_u32 v6, 0x7000, v6
    v_add_u32 v7, 0x7000, v7
    v_add_u32 v8, 0x7000, v8
    v_add_u32 v9, 0x7000, v9
    v_add_u32 v10, 0x7000, v10
    ds_read_b64_tr_b16 v[80:81], v10 offset:0
    ds_read_b64_tr_b16 v[82:83], v10 offset:768
    ds_read_b64_tr_b16 v[84:85], v10 offset:64
    ds_read_b64_tr_b16 v[86:87], v10 offset:832
    ds_read_b64_tr_b16 v[88:89], v10 offset:128
    ds_read_b64_tr_b16 v[90:91], v10 offset:896
    ds_read_b128 v[64:67], v6
    ds_read_b128 v[68:71], v7
    ds_read_b128 v[72:75], v8
    ds_read_b128 v[76:79], v9
    s_waitcnt lgkmcnt(4)
    v_dot2c_f32_bf16 v16, s33, v80
    v_dot2c_f32_bf16 v17, s33, v84
    v_dot2c_f32_bf16 v18, s33, v88
    v_dot2c_f32_bf16 v16, s33, v81
    v_dot2c_f32_bf16 v17, s33, v85
    v_dot2c_f32_bf16 v18, s33, v89
    v_dot2c_f32_bf16 v16, s33, v82
    v_dot2c_f32_bf16 v17, s33, v86
    v_dot2c_f32_bf16 v18, s33, v90
    v_dot2c_f32_bf16 v16, s33, v83
    v_dot2c_f32_bf16 v17, s33, v87
    v_dot2c_f32_bf16 v18, s33, v91
    s_waitcnt lgkmcnt(0)
    v_dot2c_f32_bf16 v12, s33, v64
    v_dot2c_f32_bf16 v13, s33, v65
    v_dot2c_f32_bf16 v12, s33, v66
    v_dot2c_f32_bf16 v13, s33, v67
    v_dot2c_f32_bf16 v12, s33, v68
    v_dot2c_f32_bf16 v13, s33, v69
    v_dot2c_f32_bf16 v12, s33, v70
    v_dot2c_f32_bf16 v13, s33, v71
    v_dot2c_f32_bf16 v12, s33, v72
    v_dot2c_f32_bf16 v13, s33, v73
    v_dot2c_f32_bf16 v12, s33, v74
    v_dot2c_f32_bf16 v13, s33, v75
    v_dot2c_f32_bf16 v12, s33, v76
    v_dot2c_f32_bf16 v13, s33, v77
    v_dot2c_f32_bf16 v12, s33, v78
    v_dot2c_f32_bf16 v13, s33, v79
    s_waitcnt vmcnt(9)
    s_barrier
    s_add_u32 m0, s35, 28672
    s_add_u32 s37, s34, 1179648
    buffer_load_dwordx4 v1, s[4:7], s37 offen lds
    s_add_u32 m0, s35, 29696
    s_add_u32 s37, s34, 1179648
    buffer_load_dwordx4 v2, s[4:7], s37 offen lds
    s_add_u32 m0, s35, 30720
    s_add_u32 s37, s34, 1179648
    buffer_load_dwordx4 v3, s[4:7], s37 offen lds
    v_add_u32 v6, 0x7000, v6
    v_add_u32 v7, 0x7000, v7
    v_add_u32 v8, 0x7000, v8
    v_add_u32 v9, 0x7000, v9
    v_add_u32 v10, 0x7000, v10
    ds_read_b64_tr_b16 v[80:81], v10 offset:0
    ds_read_b64_tr_b16 v[82:83], v10 offset:768
    ds_read_b64_tr_b16 v[84:85], v10 offset:64
    ds_read_b64_tr_b16 v[86:87], v10 offset:832
    ds_read_b64_tr_b16 v[88:89], v10 offset:128
    ds_read_b64_tr_b16 v[90:91], v10 offset:896
    ds_read_b128 v[64:67], v6
    ds_read_b128 v[68:71], v7
    ds_read_b128 v[72:75], v8
    ds_read_b128 v[76:79], v9
    s_waitcnt lgkmcnt(4)
    v_dot2c_f32_bf16 v16, s33, v80
    v_dot2c_f32_bf16 v17, s33, v84
    v_dot2c_f32_bf16 v18, s33, v88
    v_dot2c_f32_bf16 v16, s33, v81
    v_dot2c_f32_bf16 v17, s33, v85
    v_dot2c_f32_bf16 v18, s33, v89
    v_dot2c_f32_bf16 v16, s33, v82
    v_dot2c_f32_bf16 v17, s33, v86
    v_dot2c_f32_bf16 v18, s33, v90
    v_dot2c_f32_bf16 v16, s33, v83
    v_dot2c_f32_bf16 v17, s33, v87
    v_dot2c_f32_bf16 v18, s33, v91
    s_waitcnt lgkmcnt(0)
    v_dot2c_f32_bf16 v12, s33, v64
    v_dot2c_f32_bf16 v13, s33, v65
    v_dot2c_f32_bf16 v12, s33, v66
    v_dot2c_f32_bf16 v13, s33, v67
    v_dot2c_f32_bf16 v12, s33, v68
    v_dot2c_f32_bf16 v13, s33, v69
    v_dot2c_f32_bf16 v12, s33, v70
    v_dot2c_f32_bf16 v13, s33, v71
    v_dot2c_f32_bf16 v12, s33, v72
    v_dot2c_f32_bf16 v13, s33, v73
    v_dot2c_f32_bf16 v12, s33, v74
    v_dot2c_f32_bf16 v13, s33, v75
    v_dot2c_f32_bf16 v12, s33, v76
    v_dot2c_f32_bf16 v13, s33, v77
    v_dot2c_f32_bf16 v12, s33, v78
    v_dot2c_f32_bf16 v13, s33, v79
    s_waitcnt vmcnt(9)
    s_barrier
    s_add_u32 m0, s35, 57344
    s_add_u32 s37, s34, 1376256
    buffer_load_dwordx4 v1, s[4:7], s37 offen lds
    s_add_u32 m0, s35, 58368
    s_add_u32 s37, s34, 1376256
    buffer_load_dwordx4 v2, s[4:7], s37 offen lds
    s_add_u32 m0, s35, 59392
    s_add_u32 s37, s34, 1376256
    buffer_load_dwordx4 v3, s[4:7], s37 offen lds
    v_add_u32 v6, 0x7000, v6
    v_add_u32 v7, 0x7000, v7
    v_add_u32 v8, 0x7000, v8
    v_add_u32 v9, 0x7000, v9
    v_add_u32 v10, 0x7000, v10
    ds_read_b64_tr_b16 v[80:81], v10 offset:0
    ds_read_b64_tr_b16 v[82:83], v10 offset:768
    ds_read_b64_tr_b16 v[84:85], v10 offset:64
    ds_read_b64_tr_b16 v[86:87], v10 offset:832
    ds_read_b64_tr_b16 v[88:89], v10 offset:128
    ds_read_b64_tr_b16 v[90:91], v10 offset:896
    ds_read_b128 v[64:67], v6
    ds_read_b128 v[68:71], v7
    ds_read_b128 v[72:75], v8
    ds_read_b128 v[76:79], v9
    s_waitcnt lgkmcnt(4)
    v_dot2c_f32_bf16 v16, s33, v80
    v_dot2c_f32_bf16 v17, s33, v84
    v_dot2c_f32_bf16 v18, s33, v88
    v_dot2c_f32_bf16 v16, s33, v81
    v_dot2c_f32_bf16 v17, s33, v85
    v_dot2c_f32_bf16 v18, s33, v89
    v_dot2c_f32_bf16 v16, s33, v82
    v_dot2c_f32_bf16 v17, s33, v86
    v_dot2c_f32_bf16 v18, s33, v90
    v_dot2c_f32_bf16 v16, s33, v83
    v_dot2c_f32_bf16 v17, s33, v87
    v_dot2c_f32_bf16 v18, s33, v91
    s_waitcnt lgkmcnt(0)
    v_dot2c_f32_bf16 v12, s33, v64
    v_dot2c_f32_bf16 v13, s33, v65
    v_dot2c_f32_bf16 v12, s33, v66
    v_dot2c_f32_bf16 v13, s33, v67
    v_dot2c_f32_bf16 v12, s33, v68
    v_dot2c_f32_bf16 v13, s33, v69
    v_dot2c_f32_bf16 v12, s33, v70
    v_dot2c_f32_bf16 v13, s33, v71
    v_dot2c_f32_bf16 v12, s33, v72
    v_dot2c_f32_bf16 v13, s33, v73
    v_dot2c_f32_bf16 v12, s33, v74
    v_dot2c_f32_bf16 v13, s33, v75
    v_dot2c_f32_bf16 v12, s33, v76
    v_dot2c_f32_bf16 v13, s33, v77
    v_dot2c_f32_bf16 v12, s33, v78
    v_dot2c_f32_bf16 v13, s33, v79
    s_waitcnt vmcnt(9)
    s_barrier
    v_add_u32 v6, 0x7000, v6
    v_add_u32 v7, 0x7000, v7
    v_add_u32 v8, 0x7000, v8
    v_add_u32 v9, 0x7000, v9
    v_add_u32 v10, 0x7000, v10
    ds_read_b64_tr_b16 v[80:81], v10 offset:0
    ds_read_b64_tr_b16 v[82:83], v10 offset:768
    ds_read_b64_tr_b16 v[84:85], v10 offset:64
    ds_read_b64_tr_b16 v[86:87], v10 offset:832
    ds_read_b64_tr_b16 v[88:89], v10 offset:128
    ds_read_b64_tr_b16 v[90:91], v10 offset:896
    ds_read_b128 v[64:67], v6
    ds_read_b128 v[68:71], v7
    ds_read_b128 v[72:75], v8
    ds_read_b128 v[76:79], v9
    s_waitcnt lgkmcnt(4)
    v_dot2c_f32_bf16 v16, s33, v80
    v_dot2c_f32_bf16 v17, s33, v84
    v_dot2c_f32_bf16 v18, s33, v88
    v_dot2c_f32_bf16 v16, s33, v81
    v_dot2c_f32_bf16 v17, s33, v85
    v_dot2c_f32_bf16 v18, s33, v89
    v_dot2c_f32_bf16 v16, s33, v82
    v_dot2c_f32_bf16 v17, s33, v86
    v_dot2c_f32_bf16 v18, s33, v90
    v_dot2c_f32_bf16 v16, s33, v83
    v_dot2c_f32_bf16 v17, s33, v87
    v_dot2c_f32_bf16 v18, s33, v91
    s_waitcnt lgkmcnt(0)
    v_dot2c_f32_bf16 v12, s33, v64
    v_dot2c_f32_bf16 v13, s33, v65
    v_dot2c_f32_bf16 v12, s33, v66
    v_dot2c_f32_bf16 v13, s33, v67
    v_dot2c_f32_bf16 v12, s33, v68
    v_dot2c_f32_bf16 v13, s33, v69
    v_dot2c_f32_bf16 v12, s33, v70
    v_dot2c_f32_bf16 v13, s33, v71
    v_dot2c_f32_bf16 v12, s33, v72
    v_dot2c_f32_bf16 v13, s33, v73
    v_dot2c_f32_bf16 v12, s33, v74
    v_dot2c_f32_bf16 v13, s33, v75
    v_dot2c_f32_bf16 v12, s33, v76
    v_dot2c_f32_bf16 v13, s33, v77
    v_dot2c_f32_bf16 v12, s33, v78
    v_dot2c_f32_bf16 v13, s33, v79
    s_waitcnt vmcnt(6)
    s_barrier
    v_add_u32 v6, 0xfffe4000, v6
    v_add_u32 v7, 0xfffe4000, v7
    v_add_u32 v8, 0xfffe4000, v8
    v_add_u32 v9, 0xfffe4000, v9
    v_add_u32 v10, 0xfffe4000, v10
    ds_read_b64_tr_b16 v[80:81], v10 offset:0
    ds_read_b64_tr_b16 v[82:83], v10 offset:768
    ds_read_b64_tr_b16 v[84:85], v10 offset:64
    ds_read_b64_tr_b16 v[86:87], v10 offset:832
    ds_read_b64_tr_b16 v[88:89], v10 offset:128
    ds_read_b64_tr_b16 v[90:91], v10 offset:896
    ds_read_b128 v[64:67], v6
    ds_read_b128 v[68:71], v7
    ds_read_b128 v[72:75], v8
    ds_read_b128 v[76:79], v9
    s_waitcnt lgkmcnt(4)
    v_dot2c_f32_bf16 v16, s33, v80
    v_dot2c_f32_bf16 v17, s33, v84
    v_dot2c_f32_bf16 v18, s33, v88
    v_dot2c_f32_bf16 v16, s33, v81
    v_dot2c_f32_bf16 v17, s33, v85
    v_dot2c_f32_bf16 v18, s33, v89
    v_dot2c_f32_bf16 v16, s33, v82
    v_dot2c_f32_bf16 v17, s33, v86
    v_dot2c_f32_bf16 v18, s33, v90
    v_dot2c_f32_bf16 v16, s33, v83
    v_dot2c_f32_bf16 v17, s33, v87
    v_dot2c_f32_bf16 v18, s33, v91
    s_waitcnt lgkmcnt(0)
    v_dot2c_f32_bf16 v12, s33, v64
    v_dot2c_f32_bf16 v13, s33, v65
    v_dot2c_f32_bf16 v12, s33, v66
    v_dot2c_f32_bf16 v13, s33, v67
    v_dot2c_f32_bf16 v12, s33, v68
    v_dot2c_f32_bf16 v13, s33, v69
    v_dot2c_f32_bf16 v12, s33, v70
    v_dot2c_f32_bf16 v13, s33, v71
    v_dot2c_f32_bf16 v12, s33, v72
    v_dot2c_f32_bf16 v13, s33, v73
    v_dot2c_f32_bf16 v12, s33, v74
    v_dot2c_f32_bf16 v13, s33, v75
    v_dot2c_f32_bf16 v12, s33, v76
    v_dot2c_f32_bf16 v13, s33, v77
    v_dot2c_f32_bf16 v12, s33, v78
    v_dot2c_f32_bf16 v13, s33, v79
    s_waitcnt vmcnt(3)
    s_barrier
    v_add_u32 v6, 0x7000, v6
    v_add_u32 v7, 0x7000, v7
    v_add_u32 v8, 0x7000, v8
    v_add_u32 v9, 0x7000, v9
    v_add_u32 v10, 0x7000, v10
    ds_read_b64_tr_b16 v[80:81], v10 offset:0
    ds_read_b64_tr_b16 v[82:83], v10 offset:768
    ds_read_b64_tr_b16 v[84:85], v10 offset:64
    ds_read_b64_tr_b16 v[86:87], v10 offset:832
    ds_read_b64_tr_b16 v[88:89], v10 offset:128
    ds_read_b64_tr_b16 v[90:91], v10 offset:896
    ds_read_b128 v[64:67], v6
    ds_read_b128 v[68:71], v7
    ds_read_b128 v[72:75], v8
    ds_read_b128 v[76:79], v9
    s_waitcnt lgkmcnt(4)
    v_dot2c_f32_bf16 v16, s33, v80
    v_dot2c_f32_bf16 v17, s33, v84
    v_dot2c_f32_bf16 v18, s33, v88
    v_dot2c_f32_bf16 v16, s33, v81
    v_dot2c_f32_bf16 v17, s33, v85
    v_dot2c_f32_bf16 v18, s33, v89
    v_dot2c_f32_bf16 v16, s33, v82
    v_dot2c_f32_bf16 v17, s33, v86
    v_dot2c_f32_bf16 v18, s33, v90
    v_dot2c_f32_bf16 v16, s33, v83
    v_dot2c_f32_bf16 v17, s33, v87
    v_dot2c_f32_bf16 v18, s33, v91
    s_waitcnt lgkmcnt(0)
    v_dot2c_f32_bf16 v12, s33, v64
    v_dot2c_f32_bf16 v13, s33, v65
    v_dot2c_f32_bf16 v12, s33, v66
    v_dot2c_f32_bf16 v13, s33, v67
    v_dot2c_f32_bf16 v12, s33, v68
    v_dot2c_f32_bf16 v13, s33, v69
    v_dot2c_f32_bf16 v12, s33, v70
    v_dot2c_f32_bf16 v13, s33, v71
    v_dot2c_f32_bf16 v12, s33, v72
    v_dot2c_f32_bf16 v13, s33, v73
    v_dot2c_f32_bf16 v12, s33, v74
    v_dot2c_f32_bf16 v13, s33, v75
    v_dot2c_f32_bf16 v12, s33, v76
    v_dot2c_f32_bf16 v13, s33, v77
    v_dot2c_f32_bf16 v12, s33, v78
    v_dot2c_f32_bf16 v13, s33, v79
    s_waitcnt vmcnt(0)
    s_barrier
    v_add_u32 v6, 0x7000, v6
    v_add_u32 v7, 0x7000, v7
    v_add_u32 v8, 0x7000, v8
    v_add_u32 v9, 0x7000, v9
    v_add_u32 v10, 0x7000, v10
    ds_read_b64_tr_b16 v[80:81], v10 offset:0
    ds_read_b64_tr_b16 v[82:83], v10 offset:768
    ds_read_b64_tr_b16 v[84:85], v10 offset:64
    ds_read_b64_tr_b16 v[86:87], v10 offset:832
    ds_read_b64_tr_b16 v[88:89], v10 offset:128
    ds_read_b64_tr_b16 v[90:91], v10 offset:896
    ds_read_b128 v[64:67], v6
    ds_read_b128 v[68:71], v7
    ds_read_b128 v[72:75], v8
    ds_read_b128 v[76:79], v9
    s_waitcnt lgkmcnt(4)
    v_dot2c_f32_bf16 v16, s33, v80
    v_dot2c_f32_bf16 v17, s33, v84
    v_dot2c_f32_bf16 v18, s33, v88
    v_dot2c_f32_bf16 v16, s33, v81
    v_dot2c_f32_bf16 v17, s33, v85
    v_dot2c_f32_bf16 v18, s33, v89
    v_dot2c_f32_bf16 v16, s33, v82
    v_dot2c_f32_bf16 v17, s33, v86
    v_dot2c_f32_bf16 v18, s33, v90
    v_dot2c_f32_bf16 v16, s33, v83
    v_dot2c_f32_bf16 v17, s33, v87
    v_dot2c_f32_bf16 v18, s33, v91
    s_waitcnt lgkmcnt(0)
    v_dot2c_f32_bf16 v12, s33, v64
    v_dot2c_f32_bf16 v13, s33, v65
    v_dot2c_f32_bf16 v12, s33, v66
    v_dot2c_f32_bf16 v13, s33, v67
    v_dot2c_f32_bf16 v12, s33, v68
    v_dot2c_f32_bf16 v13, s33, v69
    v_dot2c_f32_bf16 v12, s33, v70
    v_dot2c_f32_bf16 v13, s33, v71
    v_dot2c_f32_bf16 v12, s33, v72
    v_dot2c_f32_bf16 v13, s33, v73
    v_dot2c_f32_bf16 v12, s33, v74
    v_dot2c_f32_bf16 v13, s33, v75
    v_dot2c_f32_bf16 v12, s33, v76
    v_dot2c_f32_bf16 v13, s33, v77
    v_dot2c_f32_bf16 v12, s33, v78
    v_dot2c_f32_bf16 v13, s33, v79
    s_lshl_b32 s37, s26, 1
    s_mul_i32 s37, s37, 384
    s_add_u32 s37, s37, 143360
    v_mul_u32_u24 v19, 384, v30
    v_lshl_add_u32 v19, v31, 2, v19
    v_add_u32 v19, s37, v19
    ds_write_b32 v19, v16 offset:0
    ds_write_b32 v19, v17 offset:128
    ds_write_b32 v19, v18 offset:256
    s_nop 3
    v_add_f32 v12, v12, v13
    v_mov_b32 v13, v12
    s_nop 1
    v_permlane32_swap_b32 v12, v13
    s_nop 1
    v_add_f32 v12, v12, v13
    s_lshl_b32 s33, s26, 8
    s_add_u32 s33, s33, 146432
    v_lshlrev_b32 v21, 2, v31
    v_add_u32 v21, s33, v21
    ds_write_b32 v21, v12
    s_waitcnt lgkmcnt(0)
    s_barrier
    s_endpgm
k1_kernel_xloader:
    v_lshrrev_b32 v19, 3, v0
    v_lshlrev_b32 v19, 10, v19
    v_lshrrev_b32 v20, 4, v0
    v_and_b32 v21, 7, v0
    v_xor_b32 v22, v21, v20
    v_lshl_add_u32 v4, v22, 4, v19
    v_xor_b32 v22, 4, v22
    v_lshl_add_u32 v5, v22, 4, v19
    s_mov_b32 s8, s20
    s_mov_b32 s9, s21
    s_mov_b32 s10, 2097152
    s_mov_b32 s11, 0x00020000
    s_lshl_b32 s36, s31, 15
    s_add_u32 m0, s32, 0
    s_add_u32 s37, s36, 0
    buffer_load_dwordx4 v4, s[8:11], s37 offen lds
    s_add_u32 m0, s32, 1024
    s_add_u32 s37, s36, 8192
    buffer_load_dwordx4 v5, s[8:11], s37 offen lds
    s_add_u32 m0, s32, 2048
    s_add_u32 s37, s36, 16384
    buffer_load_dwordx4 v4, s[8:11], s37 offen lds
    s_add_u32 m0, s32, 3072
    s_add_u32 s37, s36, 24576
    buffer_load_dwordx4 v5, s[8:11], s37 offen lds
    s_add_u32 m0, s32, 28672
    s_add_u32 s37, s36, 128
    buffer_load_dwordx4 v4, s[8:11], s37 offen lds
    s_add_u32 m0, s32, 29696
    s_add_u32 s37, s36, 8320
    buffer_load_dwordx4 v5, s[8:11], s37 offen lds
    s_add_u32 m0, s32, 30720
    s_add_u32 s37, s36, 16512
    buffer_load_dwordx4 v4, s[8:11], s37 offen lds
    s_add_u32 m0, s32, 31744
    s_add_u32 s37, s36, 24704
    buffer_load_dwordx4 v5, s[8:11], s37 offen lds
    v_mov_b32 v12, 0
    v_mov_b32 v13, 0
    s_waitcnt vmcnt(4)
    s_barrier
    s_add_u32 m0, s32, 57344
    s_add_u32 s37, s36, 256
    buffer_load_dwordx4 v4, s[8:11], s37 offen lds
    s_add_u32 m0, s32, 58368
    s_add_u32 s37, s36, 8448
    buffer_load_dwordx4 v5, s[8:11], s37 offen lds
    s_add_u32 m0, s32, 59392
    s_add_u32 s37, s36, 16640
    buffer_load_dwordx4 v4, s[8:11], s37 offen lds
    s_add_u32 m0, s32, 60416
    s_add_u32 s37, s36, 24832
    buffer_load_dwordx4 v5, s[8:11], s37 offen lds
    s_add_u32 m0, s32, 86016
    s_add_u32 s37, s36, 384
    buffer_load_dwordx4 v4, s[8:11], s37 offen lds
    s_add_u32 m0, s32, 87040
    s_add_u32 s37, s36, 8576
    buffer_load_dwordx4 v5, s[8:11], s37 offen lds
    s_add_u32 m0, s32, 88064
    s_add_u32 s37, s36, 16768
    buffer_load_dwordx4 v4, s[8:11], s37 offen lds
    s_add_u32 m0, s32, 89088
    s_add_u32 s37, s36, 24960
    buffer_load_dwordx4 v5, s[8:11], s37 offen lds
    ds_read_b128 v[64:67], v6
    ds_read_b128 v[68:71], v7
    ds_read_b128 v[72:75], v8
    ds_read_b128 v[76:79], v9
    s_waitcnt lgkmcnt(0)
    v_dot2c_f32_bf16 v12, v64, v64
    v_dot2c_f32_bf16 v13, v65, v65
    v_dot2c_f32_bf16 v12, v66, v66
    v_dot2c_f32_bf16 v13, v67, v67
    v_dot2c_f32_bf16 v12, v68, v68
    v_dot2c_f32_bf16 v13, v69, v69
    v_dot2c_f32_bf16 v12, v70, v70
    v_dot2c_f32_bf16 v13, v71, v71
    v_dot2c_f32_bf16 v12, v72, v72
    v_dot2c_f32_bf16 v13, v73, v73
    v_dot2c_f32_bf16 v12, v74, v74
    v_dot2c_f32_bf16 v13, v75, v75
    v_dot2c_f32_bf16 v12, v76, v76
    v_dot2c_f32_bf16 v13, v77, v77
    v_dot2c_f32_bf16 v12, v78, v78
    v_dot2c_f32_bf16 v13, v79, v79
    s_waitcnt vmcnt(8)
    s_barrier
    s_add_u32 m0, s32, 114688
    s_add_u32 s37, s36, 512
    buffer_load_dwordx4 v4, s[8:11], s37 offen lds
    s_add_u32 m0, s32, 115712
    s_add_u32 s37, s36, 8704
    buffer_load_dwordx4 v5, s[8:11], s37 offen lds
    s_add_u32 m0, s32, 116736
    s_add_u32 s37, s36, 16896
    buffer_load_dwordx4 v4, s[8:11], s37 offen lds
    s_add_u32 m0, s32, 117760
    s_add_u32 s37, s36, 25088
    buffer_load_dwordx4 v5, s[8:11], s37 offen lds
    s_add_u32 m0, s32, 0
    s_add_u32 s37, s36, 640
    buffer_load_dwordx4 v4, s[8:11], s37 offen lds
    s_add_u32 m0, s32, 1024
    s_add_u32 s37, s36, 8832
    buffer_load_dwordx4 v5, s[8:11], s37 offen lds
    s_add_u32 m0, s32, 2048
    s_add_u32 s37, s36, 17024
    buffer_load_dwordx4 v4, s[8:11], s37 offen lds
    s_add_u32 m0, s32, 3072
    s_add_u32 s37, s36, 25216
    buffer_load_dwordx4 v5, s[8:11], s37 offen lds
    v_add_u32 v6, 0x7000, v6
    v_add_u32 v7, 0x7000, v7
    v_add_u32 v8, 0x7000, v8
    v_add_u32 v9, 0x7000, v9
    v_add_u32 v10, 0x7000, v10
    ds_read_b128 v[64:67], v6
    ds_read_b128 v[68:71], v7
    ds_read_b128 v[72:75], v8
    ds_read_b128 v[76:79], v9
    s_waitcnt lgkmcnt(0)
    v_dot2c_f32_bf16 v12, v64, v64
    v_dot2c_f32_bf16 v13, v65, v65
    v_dot2c_f32_bf16 v12, v66, v66
    v_dot2c_f32_bf16 v13, v67, v67
    v_dot2c_f32_bf16 v12, v68, v68
    v_dot2c_f32_bf16 v13, v69, v69
    v_dot2c_f32_bf16 v12, v70, v70
    v_dot2c_f32_bf16 v13, v71, v71
    v_dot2c_f32_bf16 v12, v72, v72
    v_dot2c_f32_bf16 v13, v73, v73
    v_dot2c_f32_bf16 v12, v74, v74
    v_dot2c_f32_bf16 v13, v75, v75
    v_dot2c_f32_bf16 v12, v76, v76
    v_dot2c_f32_bf16 v13, v77, v77
    v_dot2c_f32_bf16 v12, v78, v78
    v_dot2c_f32_bf16 v13, v79, v79
    s_waitcnt vmcnt(12)
    s_barrier
    s_add_u32 m0, s32, 28672
    s_add_u32 s37, s36, 768
    buffer_load_dwordx4 v4, s[8:11], s37 offen lds
    s_add_u32 m0, s32, 29696
    s_add_u32 s37, s36, 8960
    buffer_load_dwordx4 v5, s[8:11], s37 offen lds
    s_add_u32 m0, s32, 30720
    s_add_u32 s37, s36, 17152
    buffer_load_dwordx4 v4, s[8:11], s37 offen lds
    s_add_u32 m0, s32, 31744
    s_add_u32 s37, s36, 25344
    buffer_load_dwordx4 v5, s[8:11], s37 offen lds
    v_add_u32 v6, 0x7000, v6
    v_add_u32 v7, 0x7000, v7
    v_add_u32 v8, 0x7000, v8
    v_add_u32 v9, 0x7000, v9
    v_add_u32 v10, 0x7000, v10
    ds_read_b128 v[64:67], v6
    ds_read_b128 v[68:71], v7
    ds_read_b128 v[72:75], v8
    ds_read_b128 v[76:79], v9
    s_waitcnt lgkmcnt(0)
    v_dot2c_f32_bf16 v12, v64, v64
    v_dot2c_f32_bf16 v13, v65, v65
    v_dot2c_f32_bf16 v12, v66, v66
    v_dot2c_f32_bf16 v13, v67, v67
    v_dot2c_f32_bf16 v12, v68, v68
    v_dot2c_f32_bf16 v13, v69, v69
    v_dot2c_f32_bf16 v12, v70, v70
    v_dot2c_f32_bf16 v13, v71, v71
    v_dot2c_f32_bf16 v12, v72, v72
    v_dot2c_f32_bf16 v13, v73, v73
    v_dot2c_f32_bf16 v12, v74, v74
    v_dot2c_f32_bf16 v13, v75, v75
    v_dot2c_f32_bf16 v12, v76, v76
    v_dot2c_f32_bf16 v13, v77, v77
    v_dot2c_f32_bf16 v12, v78, v78
    v_dot2c_f32_bf16 v13, v79, v79
    s_waitcnt vmcnt(12)
    s_barrier
    s_add_u32 m0, s32, 57344
    s_add_u32 s37, s36, 896
    buffer_load_dwordx4 v4, s[8:11], s37 offen lds
    s_add_u32 m0, s32, 58368
    s_add_u32 s37, s36, 9088
    buffer_load_dwordx4 v5, s[8:11], s37 offen lds
    s_add_u32 m0, s32, 59392
    s_add_u32 s37, s36, 17280
    buffer_load_dwordx4 v4, s[8:11], s37 offen lds
    s_add_u32 m0, s32, 60416
    s_add_u32 s37, s36, 25472
    buffer_load_dwordx4 v5, s[8:11], s37 offen lds
    v_add_u32 v6, 0x7000, v6
    v_add_u32 v7, 0x7000, v7
    v_add_u32 v8, 0x7000, v8
    v_add_u32 v9, 0x7000, v9
    v_add_u32 v10, 0x7000, v10
    ds_read_b128 v[64:67], v6
    ds_read_b128 v[68:71], v7
    ds_read_b128 v[72:75], v8
    ds_read_b128 v[76:79], v9
    s_waitcnt lgkmcnt(0)
    v_dot2c_f32_bf16 v12, v64, v64
    v_dot2c_f32_bf16 v13, v65, v65
    v_dot2c_f32_bf16 v12, v66, v66
    v_dot2c_f32_bf16 v13, v67, v67
    v_dot2c_f32_bf16 v12, v68, v68
    v_dot2c_f32_bf16 v13, v69, v69
    v_dot2c_f32_bf16 v12, v70, v70
    v_dot2c_f32_bf16 v13, v71, v71
    v_dot2c_f32_bf16 v12, v72, v72
    v_dot2c_f32_bf16 v13, v73, v73
    v_dot2c_f32_bf16 v12, v74, v74
    v_dot2c_f32_bf16 v13, v75, v75
    v_dot2c_f32_bf16 v12, v76, v76
    v_dot2c_f32_bf16 v13, v77, v77
    v_dot2c_f32_bf16 v12, v78, v78
    v_dot2c_f32_bf16 v13, v79, v79
    s_waitcnt vmcnt(12)
    s_barrier
    v_add_u32 v6, 0x7000, v6
    v_add_u32 v7, 0x7000, v7
    v_add_u32 v8, 0x7000, v8
    v_add_u32 v9, 0x7000, v9
    v_add_u32 v10, 0x7000, v10
    ds_read_b128 v[64:67], v6
    ds_read_b128 v[68:71], v7
    ds_read_b128 v[72:75], v8
    ds_read_b128 v[76:79], v9
    s_waitcnt lgkmcnt(0)
    v_dot2c_f32_bf16 v12, v64, v64
    v_dot2c_f32_bf16 v13, v65, v65
    v_dot2c_f32_bf16 v12, v66, v66
    v_dot2c_f32_bf16 v13, v67, v67
    v_dot2c_f32_bf16 v12, v68, v68
    v_dot2c_f32_bf16 v13, v69, v69
    v_dot2c_f32_bf16 v12, v70, v70
    v_dot2c_f32_bf16 v13, v71, v71
    v_dot2c_f32_bf16 v12, v72, v72
    v_dot2c_f32_bf16 v13, v73, v73
    v_dot2c_f32_bf16 v12, v74, v74
    v_dot2c_f32_bf16 v13, v75, v75
    v_dot2c_f32_bf16 v12, v76, v76
    v_dot2c_f32_bf16 v13, v77, v77
    v_dot2c_f32_bf16 v12, v78, v78
    v_dot2c_f32_bf16 v13, v79, v79
    s_waitcnt vmcnt(8)
    s_barrier
    v_add_u32 v6, 0xfffe4000, v6
    v_add_u32 v7, 0xfffe4000, v7
    v_add_u32 v8, 0xfffe4000, v8
    v_add_u32 v9, 0xfffe4000, v9
    v_add_u32 v10, 0xfffe4000, v10
    ds_read_b128 v[64:67], v6
    ds_read_b128 v[68:71], v7
    ds_read_b128 v[72:75], v8
    ds_read_b128 v[76:79], v9
    s_waitcnt lgkmcnt(0)
    v_dot2c_f32_bf16 v12, v64, v64
    v_dot2c_f32_bf16 v13, v65, v65
    v_dot2c_f32_bf16 v12, v66, v66
    v_dot2c_f32_bf16 v13, v67, v67
    v_dot2c_f32_bf16 v12, v68, v68
    v_dot2c_f32_bf16 v13, v69, v69
    v_dot2c_f32_bf16 v12, v70, v70
    v_dot2c_f32_bf16 v13, v71, v71
    v_dot2c_f32_bf16 v12, v72, v72
    v_dot2c_f32_bf16 v13, v73, v73
    v_dot2c_f32_bf16 v12, v74, v74
    v_dot2c_f32_bf16 v13, v75, v75
    v_dot2c_f32_bf16 v12, v76, v76
    v_dot2c_f32_bf16 v13, v77, v77
    v_dot2c_f32_bf16 v12, v78, v78
    v_dot2c_f32_bf16 v13, v79, v79
    s_waitcnt vmcnt(4)
    s_barrier
    v_add_u32 v6, 0x7000, v6
    v_add_u32 v7, 0x7000, v7
    v_add_u32 v8, 0x7000, v8
    v_add_u32 v9, 0x7000, v9
    v_add_u32 v10, 0x7000, v10
    ds_read_b128 v[64:67], v6
    ds_read_b128 v[68:71], v7
    ds_read_b128 v[72:75], v8
    ds_read_b128 v[76:79], v9
    s_waitcnt lgkmcnt(0)
    v_dot2c_f32_bf16 v12, v64, v64
    v_dot2c_f32_bf16 v13, v65, v65
    v_dot2c_f32_bf16 v12, v66, v66
    v_dot2c_f32_bf16 v13, v67, v67
    v_dot2c_f32_bf16 v12, v68, v68
    v_dot2c_f32_bf16 v13, v69, v69
    v_dot2c_f32_bf16 v12, v70, v70
    v_dot2c_f32_bf16 v13, v71, v71
    v_dot2c_f32_bf16 v12, v72, v72
    v_dot2c_f32_bf16 v13, v73, v73
    v_dot2c_f32_bf16 v12, v74, v74
    v_dot2c_f32_bf16 v13, v75, v75
    v_dot2c_f32_bf16 v12, v76, v76
    v_dot2c_f32_bf16 v13, v77, v77
    v_dot2c_f32_bf16 v12, v78, v78
    v_dot2c_f32_bf16 v13, v79, v79
    s_waitcnt vmcnt(0)
    s_barrier
    v_add_u32 v6, 0x7000, v6
    v_add_u32 v7, 0x7000, v7
    v_add_u32 v8, 0x7000, v8
    v_add_u32 v9, 0x7000, v9
    v_add_u32 v10, 0x7000, v10
    ds_read_b128 v[64:67], v6
    ds_read_b128 v[68:71], v7
    ds_read_b128 v[72:75], v8
    ds_read_b128 v[76:79], v9
    s_waitcnt lgkmcnt(0)
    v_dot2c_f32_bf16 v12, v64, v64
    v_dot2c_f32_bf16 v13, v65, v65
    v_dot2c_f32_bf16 v12, v66, v66
    v_dot2c_f32_bf16 v13, v67, v67
    v_dot2c_f32_bf16 v12, v68, v68
    v_dot2c_f32_bf16 v13, v69, v69
    v_dot2c_f32_bf16 v12, v70, v70
    v_dot2c_f32_bf16 v13, v71, v71
    v_dot2c_f32_bf16 v12, v72, v72
    v_dot2c_f32_bf16 v13, v73, v73
    v_dot2c_f32_bf16 v12, v74, v74
    v_dot2c_f32_bf16 v13, v75, v75
    v_dot2c_f32_bf16 v12, v76, v76
    v_dot2c_f32_bf16 v13, v77, v77
    v_dot2c_f32_bf16 v12, v78, v78
    v_dot2c_f32_bf16 v13, v79, v79
    s_nop 3
    v_add_f32 v12, v12, v13
    v_mov_b32 v13, v12
    s_nop 1
    v_permlane32_swap_b32 v12, v13
    s_nop 1
    v_add_f32 v12, v12, v13
    s_lshl_b32 s33, s26, 8
    s_add_u32 s33, s33, 146560
    v_lshlrev_b32 v21, 2, v31
    v_add_u32 v21, s33, v21
    ds_write_b32 v21, v12
    s_waitcnt lgkmcnt(0)
    s_barrier
    s_endpgm
k1_kernel_exit:
    s_endpgm
.globl k2_kernel
.p2align 8
.type k2_kernel,@function
k2_kernel:
    s_cmp_ge_u32 s2, 256
    s_cbranch_scc1 k2_kernel_exit
    s_load_dwordx2 s[24:25], s[0:1], 72
    s_load_dwordx2 s[20:21], s[0:1], 16
    s_load_dwordx2 s[22:23], s[0:1], 32
    s_load_dwordx2 s[18:19], s[0:1], 48
    v_lshrrev_b32 v1, 6, v0
    v_lshlrev_b32 v2, 3, v0
    v_and_b32 v0, 63, v0
    v_readfirstlane_b32 s26, v1
    v_lshlrev_b32 v4, 4, v0
    v_lshrrev_b32 v30, 5, v0
    v_add_u32 v2, 131072, v2
    v_mov_b32 v12, 0x3f803f80
    v_mov_b32 v13, 0x3f803f80
    ds_write_b64 v2, v[12:13]
    v_mov_b32 v3, 139264
    v_mov_b32 v12, 0
    ds_write_b32 v3, v12
    s_and_b32 s27, s2, 7
    s_lshl_b32 s27, s27, 2
    s_bfe_u32 s28, s2, 0x20003
    s_add_u32 s27, s27, s28
    s_lshr_b32 s28, s2, 5
    s_and_b32 s29, s26, 3
    s_lshr_b32 s30, s26, 2
    s_waitcnt lgkmcnt(0)
    s_mov_b32 s8, s24
    s_mov_b32 s9, s25
    s_mov_b32 s10, 33554432
    s_mov_b32 s11, 0x00020000
    s_lshl_b32 s31, s27, 16
    s_and_b32 s34, s26, 1
    s_bfe_u32 s35, s26, 0x20001
    s_lshr_b32 s36, s26, 3
    s_lshl_b32 s35, s35, 14
    s_lshl_b32 s36, s36, 10
    s_add_u32 s35, s35, s36
    s_lshl_b32 s36, s34, 16
    s_add_u32 s36, s36, s35
    s_lshl_b32 s37, s34, 21
    s_add_u32 s37, s37, s35
    s_add_u32 s37, s37, s31
    s_add_u32 s37, s37, 2097152
    s_add_u32 m0, s36, 0
    s_add_u32 s38, s37, 0
    buffer_load_dwordx4 v4, s[8:11], s38 offen lds
    s_lshl_b32 s32, s28, 3
    s_lshl_b32 s33, s29, 1
    s_add_u32 s32, s32, s33
    s_lshl_b32 s33, s32, 10
    s_add_u32 s33, s33, s31
    buffer_load_dwordx4 v[8:11], v4, s[8:11], s33 offen
    buffer_load_dwordx4 v[12:15], v4, s[8:11], s33 offen offset:1024
    s_add_u32 m0, s36, 2048
    s_add_u32 s38, s37, 2048
    buffer_load_dwordx4 v4, s[8:11], s38 offen lds
    s_add_u32 m0, s36, 4096
    s_add_u32 s38, s37, 4096
    buffer_load_dwordx4 v4, s[8:11], s38 offen lds
    s_lshl_b32 s38, s30, 14
    v_add_u32 v5, s38, v4
    v_bfe_u32 v19, v0, 2, 2
    v_lshl_add_u32 v19, v30, 2, v19
    v_lshlrev_b32 v19, 5, v19
    v_and_b32 v20, 3, v0
    v_lshl_add_u32 v19, v20, 3, v19
    v_add_u32 v19, 65536, v19
    v_add_u32 v19, s38, v19
    v_xor_b32 v20, 1, v30
    v_lshlrev_b32 v20, 7, v20
    v_and_b32 v21, 15, v0
    v_lshl_add_u32 v20, v21, 3, v20
    v_add_u32 v20, 131072, v20
    v_bfe_u32 v21, v0, 4, 1
    v_cmp_eq_u32 vcc, 0, v21
    v_cndmask_b32 v6, v20, v19, vcc
    v_mov_b32 v21, 4096
    v_cndmask_b32 v7, 0, v21, vcc
    v_mov_b32 v2, v6
    v_mov_b32 v1, v5
    v_mov_b32 v48, 0
    v_mov_b32 v49, 0
    v_mov_b32 v50, 0
    v_mov_b32 v51, 0
    v_mov_b32 v52, 0
    v_mov_b32 v53, 0
    v_mov_b32 v54, 0
    v_mov_b32 v55, 0
    v_mov_b32 v56, 0
    v_mov_b32 v57, 0
    v_mov_b32 v58, 0
    v_mov_b32 v59, 0
    v_mov_b32 v60, 0
    v_mov_b32 v61, 0
    v_mov_b32 v62, 0
    v_mov_b32 v63, 0
    v_mov_b32 v64, 0
    v_mov_b32 v65, 0
    v_mov_b32 v66, 0
    v_mov_b32 v67, 0
    v_mov_b32 v68, 0
    v_mov_b32 v69, 0
    v_mov_b32 v70, 0
    v_mov_b32 v71, 0
    v_mov_b32 v72, 0
    v_mov_b32 v73, 0
    v_mov_b32 v74, 0
    v_mov_b32 v75, 0
    v_mov_b32 v76, 0
    v_mov_b32 v77, 0
    v_mov_b32 v78, 0
    v_mov_b32 v79, 0
    s_lshr_b32 s39, s2, 3
    s_lshl_b32 s39, s39, 4
    s_add_u32 s39, s39, s26
    s_mov_b32 s12, s22
    s_mov_b32 s13, s23
    s_mov_b32 s14, 1409024
    s_mov_b32 s15, 0x00020000
    s_mov_b32 s40, 0
    s_cmp_ge_u32 s39, 172
    s_cselect_b32 s12, s20, s12
    s_cselect_b32 s13, s21, s13
    s_cselect_b32 s14, 524288, s14
    s_cselect_b32 s40, 172, s40
    s_cmp_ge_u32 s39, 236
    s_cselect_b32 s12, s18, s12
    s_cselect_b32 s13, s19, s13
    s_cselect_b32 s14, 1409024, s14
    s_cselect_b32 s40, 236, s40
    s_sub_u32 s39, s39, s40
    s_lshl_b32 s39, s39, 13
    v_lshlrev_b32 v3, 7, v0
    v_add_u32 v3, s39, v3
    s_waitcnt vmcnt(0)
    s_barrier
    s_add_u32 m0, s36, 6144
    s_add_u32 s38, s37, 6144
    buffer_load_dwordx4 v4, s[8:11], s38 offen lds
    s_add_u32 m0, s36, 8192
    s_add_u32 s38, s37, 8192
    buffer_load_dwordx4 v4, s[8:11], s38 offen lds
    s_add_u32 m0, s36, 10240
    s_add_u32 s38, s37, 10240
    buffer_load_dwordx4 v4, s[8:11], s38 offen lds
    s_add_u32 m0, s36, 12288
    s_add_u32 s38, s37, 12288
    buffer_load_dwordx4 v4, s[8:11], s38 offen lds
    s_add_u32 m0, s36, 14336
    s_add_u32 s38, s37, 14336
    buffer_load_dwordx4 v4, s[8:11], s38 offen lds
    ds_read_b128 v[88:91], v5 offset:0
    ds_read_b128 v[92:95], v5 offset:1024
    ds_read_b64_tr_b16 v[96:97], v6 offset:0
    ds_read_b64_tr_b16 v[98:99], v6 offset:256
    ds_read_b64_tr_b16 v[100:101], v6 offset:512
    ds_read_b64_tr_b16 v[102:103], v6 offset:768
    v_mov_b32 v112, 0
    v_mov_b32 v104, 0
    v_mov_b32 v113, 0
    v_mov_b32 v105, 0
    v_mov_b32 v114, 0
    v_mov_b32 v106, 0
    v_mov_b32 v115, 0
    v_mov_b32 v107, 0
    v_mov_b32 v116, 0
    v_mov_b32 v108, 0
    v_mov_b32 v117, 0
    v_mov_b32 v109, 0
    v_mov_b32 v118, 0
    v_mov_b32 v110, 0
    v_mov_b32 v119, 0
    v_mov_b32 v111, 0
    s_waitcnt lgkmcnt(5)
    v_mfma_f32_32x32x16_bf16 v[16:31], v[88:91], v[8:11], 0
    s_mov_b32 s42, 0
    s_nop 7
    s_nop 7
k2_kernel_loop:
    v_exp_f32 v16, v16
    v_exp_f32 v17, v17
    v_mfma_f32_32x32x16_bf16 v[64:79], v[104:107], v[112:115], v[64:79]
    v_exp_f32 v18, v18
    v_exp_f32 v19, v19
    v_exp_f32 v20, v20
    v_exp_f32 v21, v21
    v_mfma_f32_32x32x16_bf16 v[64:79], v[108:111], v[116:119], v[64:79]
    v_exp_f32 v22, v22
    v_exp_f32 v23, v23
    v_exp_f32 v24, v24
    v_exp_f32 v25, v25
    v_mfma_f32_32x32x16_bf16 v[32:47], v[88:91], v[12:15], 0
    v_exp_f32 v26, v26
    v_exp_f32 v27, v27
    v_exp_f32 v28, v28
    v_exp_f32 v29, v29
    v_exp_f32 v30, v30
    v_exp_f32 v31, v31
    v_cvt_pk_bf16_f32 v80, v16, v17
    v_cvt_pk_bf16_f32 v81, v18, v19
    v_cvt_pk_bf16_f32 v82, v20, v21
    v_cvt_pk_bf16_f32 v83, v22, v23
    v_cvt_pk_bf16_f32 v84, v24, v25
    v_cvt_pk_bf16_f32 v85, v26, v27
    v_cvt_pk_bf16_f32 v86, v28, v29
    v_cvt_pk_bf16_f32 v87, v30, v31
    s_waitcnt lgkmcnt(0)
    ds_read_b64_tr_b16 v[104:105], v6 offset:1024
    ds_read_b64_tr_b16 v[106:107], v6 offset:1280
    ds_read_b64_tr_b16 v[108:109], v6 offset:1536
    ds_read_b64_tr_b16 v[110:111], v6 offset:1792
    ds_read_b128 v[88:91], v5 offset:2048
    v_exp_f32 v32, v32
    v_exp_f32 v33, v33
    v_mfma_f32_32x32x16_bf16 v[48:63], v[96:99], v[80:83], v[48:63]
    v_exp_f32 v34, v34
    v_exp_f32 v35, v35
    v_exp_f32 v36, v36
    v_exp_f32 v37, v37
    v_mfma_f32_32x32x16_bf16 v[48:63], v[100:103], v[84:87], v[48:63]
    v_exp_f32 v38, v38
    v_exp_f32 v39, v39
    v_exp_f32 v40, v40
    v_exp_f32 v41, v41
    v_mfma_f32_32x32x16_bf16 v[16:31], v[92:95], v[8:11], 0
    v_exp_f32 v42, v42
    v_exp_f32 v43, v43
    v_exp_f32 v44, v44
    v_exp_f32 v45, v45
    v_exp_f32 v46, v46
    v_exp_f32 v47, v47
    v_cvt_pk_bf16_f32 v112, v32, v33
    v_cvt_pk_bf16_f32 v113, v34, v35
    v_cvt_pk_bf16_f32 v114, v36, v37
    v_cvt_pk_bf16_f32 v115, v38, v39
    v_cvt_pk_bf16_f32 v116, v40, v41
    v_cvt_pk_bf16_f32 v117, v42, v43
    v_cvt_pk_bf16_f32 v118, v44, v45
    v_cvt_pk_bf16_f32 v119, v46, v47
    v_exp_f32 v16, v16
    v_exp_f32 v17, v17
    v_mfma_f32_32x32x16_bf16 v[64:79], v[96:99], v[112:115], v[64:79]
    v_exp_f32 v18, v18
    v_exp_f32 v19, v19
    v_exp_f32 v20, v20
    v_exp_f32 v21, v21
    v_mfma_f32_32x32x16_bf16 v[64:79], v[100:103], v[116:119], v[64:79]
    v_exp_f32 v22, v22
    v_exp_f32 v23, v23
    v_exp_f32 v24, v24
    v_exp_f32 v25, v25
    v_mfma_f32_32x32x16_bf16 v[32:47], v[92:95], v[12:15], 0
    v_exp_f32 v26, v26
    v_exp_f32 v27, v27
    v_exp_f32 v28, v28
    v_exp_f32 v29, v29
    v_exp_f32 v30, v30
    v_exp_f32 v31, v31
    v_cvt_pk_bf16_f32 v80, v16, v17
    v_cvt_pk_bf16_f32 v81, v18, v19
    v_cvt_pk_bf16_f32 v82, v20, v21
    v_cvt_pk_bf16_f32 v83, v22, v23
    v_cvt_pk_bf16_f32 v84, v24, v25
    v_cvt_pk_bf16_f32 v85, v26, v27
    v_cvt_pk_bf16_f32 v86, v28, v29
    v_cvt_pk_bf16_f32 v87, v30, v31
    s_waitcnt lgkmcnt(0)
    ds_read_b64_tr_b16 v[96:97], v6 offset:2048
    ds_read_b64_tr_b16 v[98:99], v6 offset:2304
    ds_read_b64_tr_b16 v[100:101], v6 offset:2560
    ds_read_b64_tr_b16 v[102:103], v6 offset:2816
    ds_read_b128 v[92:95], v5 offset:3072
    v_exp_f32 v32, v32
    v_exp_f32 v33, v33
    v_mfma_f32_32x32x16_bf16 v[48:63], v[104:107], v[80:83], v[48:63]
    v_exp_f32 v34, v34
    v_exp_f32 v35, v35
    v_exp_f32 v36, v36
    v_exp_f32 v37, v37
    v_mfma_f32_32x32x16_bf16 v[48:63], v[108:111], v[84:87], v[48:63]
    v_exp_f32 v38, v38
    v_exp_f32 v39, v39
    v_exp_f32 v40, v40
    v_exp_f32 v41, v41
    v_mfma_f32_32x32x16_bf16 v[16:31], v[88:91], v[8:11], 0
    v_exp_f32 v42, v42
    v_exp_f32 v43, v43
    v_exp_f32 v44, v44
    v_exp_f32 v45, v45
    v_exp_f32 v46, v46
    v_exp_f32 v47, v47
    v_cvt_pk_bf16_f32 v112, v32, v33
    v_cvt_pk_bf16_f32 v113, v34, v35
    v_cvt_pk_bf16_f32 v114, v36, v37
    v_cvt_pk_bf16_f32 v115, v38, v39
    v_cvt_pk_bf16_f32 v116, v40, v41
    v_cvt_pk_bf16_f32 v117, v42, v43
    v_cvt_pk_bf16_f32 v118, v44, v45
    v_cvt_pk_bf16_f32 v119, v46, v47
    v_exp_f32 v16, v16
    v_exp_f32 v17, v17
    v_mfma_f32_32x32x16_bf16 v[64:79], v[104:107], v[112:115], v[64:79]
    v_exp_f32 v18, v18
    v_exp_f32 v19, v19
    v_exp_f32 v20, v20
    v_exp_f32 v21, v21
    v_mfma_f32_32x32x16_bf16 v[64:79], v[108:111], v[116:119], v[64:79]
    v_exp_f32 v22, v22
    v_exp_f32 v23, v23
    v_exp_f32 v24, v24
    v_exp_f32 v25, v25
    v_mfma_f32_32x32x16_bf16 v[32:47], v[88:91], v[12:15], 0
    v_exp_f32 v26, v26
    v_exp_f32 v27, v27
    v_exp_f32 v28, v28
    v_exp_f32 v29, v29
    v_exp_f32 v30, v30
    v_exp_f32 v31, v31
    v_cvt_pk_bf16_f32 v80, v16, v17
    v_cvt_pk_bf16_f32 v81, v18, v19
    v_cvt_pk_bf16_f32 v82, v20, v21
    v_cvt_pk_bf16_f32 v83, v22, v23
    v_cvt_pk_bf16_f32 v84, v24, v25
    v_cvt_pk_bf16_f32 v85, v26, v27
    v_cvt_pk_bf16_f32 v86, v28, v29
    v_cvt_pk_bf16_f32 v87, v30, v31
    s_waitcnt lgkmcnt(0)
    ds_read_b64_tr_b16 v[104:105], v6 offset:3072
    ds_read_b64_tr_b16 v[106:107], v6 offset:3328
    ds_read_b64_tr_b16 v[108:109], v6 offset:3584
    ds_read_b64_tr_b16 v[110:111], v6 offset:3840
    ds_read_b128 v[88:91], v5 offset:4096
    v_exp_f32 v32, v32
    v_exp_f32 v33, v33
    v_mfma_f32_32x32x16_bf16 v[48:63], v[96:99], v[80:83], v[48:63]
    v_exp_f32 v34, v34
    v_exp_f32 v35, v35
    v_exp_f32 v36, v36
    v_exp_f32 v37, v37
    v_mfma_f32_32x32x16_bf16 v[48:63], v[100:103], v[84:87], v[48:63]
    v_exp_f32 v38, v38
    v_exp_f32 v39, v39
    v_exp_f32 v40, v40
    v_exp_f32 v41, v41
    v_mfma_f32_32x32x16_bf16 v[16:31], v[92:95], v[8:11], 0
    v_exp_f32 v42, v42
    v_exp_f32 v43, v43
    v_exp_f32 v44, v44
    v_exp_f32 v45, v45
    v_exp_f32 v46, v46
    v_exp_f32 v47, v47
    v_cvt_pk_bf16_f32 v112, v32, v33
    v_cvt_pk_bf16_f32 v113, v34, v35
    v_cvt_pk_bf16_f32 v114, v36, v37
    v_cvt_pk_bf16_f32 v115, v38, v39
    v_cvt_pk_bf16_f32 v116, v40, v41
    v_cvt_pk_bf16_f32 v117, v42, v43
    v_cvt_pk_bf16_f32 v118, v44, v45
    v_cvt_pk_bf16_f32 v119, v46, v47
    v_exp_f32 v16, v16
    v_exp_f32 v17, v17
    v_mfma_f32_32x32x16_bf16 v[64:79], v[96:99], v[112:115], v[64:79]
    v_exp_f32 v18, v18
    v_exp_f32 v19, v19
    v_exp_f32 v20, v20
    v_exp_f32 v21, v21
    v_mfma_f32_32x32x16_bf16 v[64:79], v[100:103], v[116:119], v[64:79]
    v_exp_f32 v22, v22
    v_exp_f32 v23, v23
    v_exp_f32 v24, v24
    v_exp_f32 v25, v25
    v_mfma_f32_32x32x16_bf16 v[32:47], v[92:95], v[12:15], 0
    v_exp_f32 v26, v26
    v_exp_f32 v27, v27
    v_exp_f32 v28, v28
    v_exp_f32 v29, v29
    v_exp_f32 v30, v30
    v_exp_f32 v31, v31
    v_cvt_pk_bf16_f32 v80, v16, v17
    v_cvt_pk_bf16_f32 v81, v18, v19
    v_cvt_pk_bf16_f32 v82, v20, v21
    v_cvt_pk_bf16_f32 v83, v22, v23
    v_cvt_pk_bf16_f32 v84, v24, v25
    v_cvt_pk_bf16_f32 v85, v26, v27
    v_cvt_pk_bf16_f32 v86, v28, v29
    v_cvt_pk_bf16_f32 v87, v30, v31
    s_waitcnt lgkmcnt(0)
    ds_read_b64_tr_b16 v[96:97], v6 offset:4096
    ds_read_b64_tr_b16 v[98:99], v6 offset:4352
    ds_read_b64_tr_b16 v[100:101], v6 offset:4608
    ds_read_b64_tr_b16 v[102:103], v6 offset:4864
    ds_read_b128 v[92:95], v5 offset:5120
    v_exp_f32 v32, v32
    v_exp_f32 v33, v33
    v_mfma_f32_32x32x16_bf16 v[48:63], v[104:107], v[80:83], v[48:63]
    v_exp_f32 v34, v34
    v_exp_f32 v35, v35
    v_exp_f32 v36, v36
    v_exp_f32 v37, v37
    v_mfma_f32_32x32x16_bf16 v[48:63], v[108:111], v[84:87], v[48:63]
    v_exp_f32 v38, v38
    v_exp_f32 v39, v39
    v_exp_f32 v40, v40
    v_exp_f32 v41, v41
    v_mfma_f32_32x32x16_bf16 v[16:31], v[88:91], v[8:11], 0
    v_exp_f32 v42, v42
    v_exp_f32 v43, v43
    v_exp_f32 v44, v44
    v_exp_f32 v45, v45
    v_exp_f32 v46, v46
    v_exp_f32 v47, v47
    v_cvt_pk_bf16_f32 v112, v32, v33
    v_cvt_pk_bf16_f32 v113, v34, v35
    v_cvt_pk_bf16_f32 v114, v36, v37
    v_cvt_pk_bf16_f32 v115, v38, v39
    v_cvt_pk_bf16_f32 v116, v40, v41
    v_cvt_pk_bf16_f32 v117, v42, v43
    v_cvt_pk_bf16_f32 v118, v44, v45
    v_cvt_pk_bf16_f32 v119, v46, v47
    v_add_u32 v5, 4096, v5
    v_add_u32 v6, v6, v7
    s_add_u32 s42, s42, 1
    s_cmp_lg_u32 s42, 1
    s_cbranch_scc1 k2_kernel_5
    s_waitcnt vmcnt(0)
    s_barrier
    buffer_load_dword v120, v3, s[12:15], 0 offen
k2_kernel_5:
    s_cmp_lt_u32 s42, 4
    s_cbranch_scc1 k2_kernel_loop
    v_mfma_f32_32x32x16_bf16 v[64:79], v[104:107], v[112:115], v[64:79]
    v_mfma_f32_32x32x16_bf16 v[64:79], v[108:111], v[116:119], v[64:79]
    s_waitcnt lgkmcnt(0)
    s_nop 7
    s_nop 7
    v_mov_b32 v20, 0x5d800000
    v_mov_b32 v21, 0x21800000
    v_mov_b32 v22, 0x7f7fffff
    v_pk_add_f32 v[24:25], v[48:49], v[50:51]
    v_pk_add_f32 v[28:29], v[52:53], v[54:55]
    v_pk_add_f32 v[24:25], v[24:25], v[28:29]
    v_add_f32 v24, v24, v25
    v_pk_add_f32 v[26:27], v[64:65], v[66:67]
    v_pk_add_f32 v[30:31], v[68:69], v[70:71]
    v_pk_add_f32 v[26:27], v[26:27], v[30:31]
    v_add_f32 v26, v26, v27
    v_cmp_le_f32 vcc, v56, v20
    v_cmp_ge_f32 s[44:45], v56, v21
    v_cmp_le_f32 s[46:47], |v24|, v22
    v_cmp_le_f32 s[48:49], v72, v20
    v_cmp_ge_f32 s[36:37], v72, v21
    v_cmp_le_f32 s[38:39], |v26|, v22
    s_and_b64 vcc, vcc, s[44:45]
    s_and_b64 s[46:47], s[46:47], s[48:49]
    s_and_b64 s[36:37], s[36:37], s[38:39]
    s_and_b64 vcc, vcc, s[46:47]
    s_and_b64 vcc, vcc, s[36:37]
    v_mov_b32 v22, 139264
    s_not_b64 vcc, vcc
    s_cmp_eq_u64 vcc, 0
    s_cbranch_scc1 k2_kernel_6
    v_mov_b32 v21, 1
    ds_write_b32 v22, v21
k2_kernel_6:
    s_waitcnt lgkmcnt(0)
    s_barrier
    ds_read_b32 v21, v22
    s_waitcnt lgkmcnt(0)
    v_readfirstlane_b32 s44, v21
    s_cmp_eq_u32 s44, 0
    s_cmp_eq_u32 s44, 0
    s_cbranch_scc1 k2_kernel_comb
    s_waitcnt vmcnt(0)
    v_mov_b32 v3, v4
    s_mov_b32 s42, 0
    v_mov_b32 v7, 0xff800000
k2_kernel_7:
    ds_read_b128 v[88:91], v3
    v_add_u32 v3, 1024, v3
    s_waitcnt lgkmcnt(0)
    v_mfma_f32_32x32x16_bf16 v[16:31], v[88:91], v[8:11], 0
    s_add_u32 s42, s42, 1
    s_nop 7
    s_nop 7
    v_max3_f32 v7, v7, v16, v17
    v_max3_f32 v7, v7, v18, v19
    v_max3_f32 v7, v7, v20, v21
    v_max3_f32 v7, v7, v22, v23
    v_max3_f32 v7, v7, v24, v25
    v_max3_f32 v7, v7, v26, v27
    v_max3_f32 v7, v7, v28, v29
    v_max3_f32 v7, v7, v30, v31
    s_cmp_lt_u32 s42, 64
    s_cbranch_scc1 k2_kernel_7
    v_mov_b32 v21, v7
    s_nop 1
    v_permlane32_swap_b32 v7, v21
    s_nop 1
    v_max_f32 v7, v7, v21
    v_sub_f32 v7, 0, v7
    v_mov_b32 v112, v7
    v_mov_b32 v113, v7
    v_mov_b32 v114, v7
    v_mov_b32 v115, v7
    v_mov_b32 v116, v7
    v_mov_b32 v117, v7
    v_mov_b32 v118, v7
    v_mov_b32 v119, v7
    v_mov_b32 v120, v7
    v_mov_b32 v121, v7
    v_mov_b32 v122, v7
    v_mov_b32 v123, v7
    v_mov_b32 v124, v7
    v_mov_b32 v125, v7
    v_mov_b32 v126, v7
    v_mov_b32 v127, v7
    v_mov_b32 v48, 0
    v_mov_b32 v49, 0
    v_mov_b32 v50, 0
    v_mov_b32 v51, 0
    v_mov_b32 v52, 0
    v_mov_b32 v53, 0
    v_mov_b32 v54, 0
    v_mov_b32 v55, 0
    v_mov_b32 v56, 0
    v_mov_b32 v57, 0
    v_mov_b32 v58, 0
    v_mov_b32 v59, 0
    v_mov_b32 v60, 0
    v_mov_b32 v61, 0
    v_mov_b32 v62, 0
    v_mov_b32 v63, 0
    v_mov_b32 v5, v1
    v_mov_b32 v6, v2
    v_bfe_u32 v21, v0, 4, 1
    v_cmp_eq_u32 vcc, 0, v21
    v_mov_b32 v21, 1024
    s_nop 1
    v_cndmask_b32 v7, 0, v21, vcc
    s_mov_b32 s42, 0
k2_kernel_8:
    ds_read_b128 v[88:91], v5 offset:0
    ds_read_b64_tr_b16 v[96:97], v6 offset:0
    ds_read_b64_tr_b16 v[98:99], v6 offset:256
    ds_read_b64_tr_b16 v[100:101], v6 offset:512
    ds_read_b64_tr_b16 v[102:103], v6 offset:768
    v_add_u32 v5, 1024, v5
    v_add_u32 v6, v6, v7
    s_waitcnt lgkmcnt(0)
    v_mfma_f32_32x32x16_bf16 v[16:31], v[88:91], v[8:11], v[112:127]
    s_add_u32 s42, s42, 1
    s_nop 7
    s_nop 7
    v_exp_f32 v16, v16
    v_exp_f32 v17, v17
    v_exp_f32 v18, v18
    v_exp_f32 v19, v19
    v_exp_f32 v20, v20
    v_exp_f32 v21, v21
    v_exp_f32 v22, v22
    v_exp_f32 v23, v23
    v_exp_f32 v24, v24
    v_exp_f32 v25, v25
    v_exp_f32 v26, v26
    v_exp_f32 v27, v27
    v_exp_f32 v28, v28
    v_exp_f32 v29, v29
    v_exp_f32 v30, v30
    v_exp_f32 v31, v31
    v_cvt_pk_bf16_f32 v80, v16, v17
    v_cvt_pk_bf16_f32 v81, v18, v19
    v_cvt_pk_bf16_f32 v82, v20, v21
    v_cvt_pk_bf16_f32 v83, v22, v23
    v_cvt_pk_bf16_f32 v84, v24, v25
    v_cvt_pk_bf16_f32 v85, v26, v27
    v_cvt_pk_bf16_f32 v86, v28, v29
    v_cvt_pk_bf16_f32 v87, v30, v31
    s_nop 1
    v_mfma_f32_32x32x16_bf16 v[48:63], v[96:99], v[80:83], v[48:63]
    v_mfma_f32_32x32x16_bf16 v[48:63], v[100:103], v[84:87], v[48:63]
    s_cmp_lt_u32 s42, 16
    s_cbranch_scc1 k2_kernel_8
    v_mov_b32 v3, v4
    s_mov_b32 s42, 0
    v_mov_b32 v7, 0xff800000
k2_kernel_9:
    ds_read_b128 v[88:91], v3
    v_add_u32 v3, 1024, v3
    s_waitcnt lgkmcnt(0)
    v_mfma_f32_32x32x16_bf16 v[16:31], v[88:91], v[12:15], 0
    s_add_u32 s42, s42, 1
    s_nop 7
    s_nop 7
    v_max3_f32 v7, v7, v16, v17
    v_max3_f32 v7, v7, v18, v19
    v_max3_f32 v7, v7, v20, v21
    v_max3_f32 v7, v7, v22, v23
    v_max3_f32 v7, v7, v24, v25
    v_max3_f32 v7, v7, v26, v27
    v_max3_f32 v7, v7, v28, v29
    v_max3_f32 v7, v7, v30, v31
    s_cmp_lt_u32 s42, 64
    s_cbranch_scc1 k2_kernel_9
    v_mov_b32 v21, v7
    s_nop 1
    v_permlane32_swap_b32 v7, v21
    s_nop 1
    v_max_f32 v7, v7, v21
    v_sub_f32 v7, 0, v7
    v_mov_b32 v112, v7
    v_mov_b32 v113, v7
    v_mov_b32 v114, v7
    v_mov_b32 v115, v7
    v_mov_b32 v116, v7
    v_mov_b32 v117, v7
    v_mov_b32 v118, v7
    v_mov_b32 v119, v7
    v_mov_b32 v120, v7
    v_mov_b32 v121, v7
    v_mov_b32 v122, v7
    v_mov_b32 v123, v7
    v_mov_b32 v124, v7
    v_mov_b32 v125, v7
    v_mov_b32 v126, v7
    v_mov_b32 v127, v7
    v_mov_b32 v64, 0
    v_mov_b32 v65, 0
    v_mov_b32 v66, 0
    v_mov_b32 v67, 0
    v_mov_b32 v68, 0
    v_mov_b32 v69, 0
    v_mov_b32 v70, 0
    v_mov_b32 v71, 0
    v_mov_b32 v72, 0
    v_mov_b32 v73, 0
    v_mov_b32 v74, 0
    v_mov_b32 v75, 0
    v_mov_b32 v76, 0
    v_mov_b32 v77, 0
    v_mov_b32 v78, 0
    v_mov_b32 v79, 0
    v_mov_b32 v5, v1
    v_mov_b32 v6, v2
    v_bfe_u32 v21, v0, 4, 1
    v_cmp_eq_u32 vcc, 0, v21
    v_mov_b32 v21, 1024
    s_nop 1
    v_cndmask_b32 v7, 0, v21, vcc
    s_mov_b32 s42, 0
k2_kernel_10:
    ds_read_b128 v[88:91], v5 offset:0
    ds_read_b64_tr_b16 v[96:97], v6 offset:0
    ds_read_b64_tr_b16 v[98:99], v6 offset:256
    ds_read_b64_tr_b16 v[100:101], v6 offset:512
    ds_read_b64_tr_b16 v[102:103], v6 offset:768
    v_add_u32 v5, 1024, v5
    v_add_u32 v6, v6, v7
    s_waitcnt lgkmcnt(0)
    v_mfma_f32_32x32x16_bf16 v[16:31], v[88:91], v[12:15], v[112:127]
    s_add_u32 s42, s42, 1
    s_nop 7
    s_nop 7
    v_exp_f32 v16, v16
    v_exp_f32 v17, v17
    v_exp_f32 v18, v18
    v_exp_f32 v19, v19
    v_exp_f32 v20, v20
    v_exp_f32 v21, v21
    v_exp_f32 v22, v22
    v_exp_f32 v23, v23
    v_exp_f32 v24, v24
    v_exp_f32 v25, v25
    v_exp_f32 v26, v26
    v_exp_f32 v27, v27
    v_exp_f32 v28, v28
    v_exp_f32 v29, v29
    v_exp_f32 v30, v30
    v_exp_f32 v31, v31
    v_cvt_pk_bf16_f32 v80, v16, v17
    v_cvt_pk_bf16_f32 v81, v18, v19
    v_cvt_pk_bf16_f32 v82, v20, v21
    v_cvt_pk_bf16_f32 v83, v22, v23
    v_cvt_pk_bf16_f32 v84, v24, v25
    v_cvt_pk_bf16_f32 v85, v26, v27
    v_cvt_pk_bf16_f32 v86, v28, v29
    v_cvt_pk_bf16_f32 v87, v30, v31
    s_nop 1
    v_mfma_f32_32x32x16_bf16 v[64:79], v[96:99], v[80:83], v[64:79]
    v_mfma_f32_32x32x16_bf16 v[64:79], v[100:103], v[84:87], v[64:79]
    s_cmp_lt_u32 s42, 16
    s_cbranch_scc1 k2_kernel_10
    s_nop 7
    s_nop 7
    s_barrier
k2_kernel_comb:
    s_lshl_b32 s43, s29, 3
    s_mul_i32 s43, s43, 2304
    s_mul_i32 s44, s30, 4608
    s_add_u32 s44, s44, s43
    v_add_u32 v19, s44, v4
    v_lshlrev_b32 v20, 2, v0
    v_add_u32 v20, s44, v20
    s_cmp_eq_u32 s30, 0
    s_cbranch_scc1 k2_kernel_11
    ds_write_b128 v19, v[48:51] offset:0
    ds_write_b128 v19, v[52:55] offset:1024
    ds_write_b32 v20, v56 offset:2048
k2_kernel_11:
    s_cmp_eq_u32 s30, 1
    s_cbranch_scc1 k2_kernel_12
    ds_write_b128 v19, v[64:67] offset:2304
    ds_write_b128 v19, v[68:71] offset:3328
    ds_write_b32 v20, v72 offset:4352
k2_kernel_12:
    s_waitcnt lgkmcnt(0)
    s_barrier
    s_cmp_ge_u32 s30, 2
    s_cbranch_scc1 k2_kernel_done
    s_cmp_eq_u32 s30, 0
    s_cbranch_scc1 k2_kernel_13
    v_mov_b32 v48, v64
    v_mov_b32 v49, v65
    v_mov_b32 v50, v66
    v_mov_b32 v51, v67
    v_mov_b32 v52, v68
    v_mov_b32 v53, v69
    v_mov_b32 v54, v70
    v_mov_b32 v55, v71
    v_mov_b32 v56, v72
k2_kernel_13:
    s_mul_i32 s44, s30, 2304
    s_add_u32 s44, s44, s43
    v_add_u32 v19, s44, v4
    v_lshlrev_b32 v20, 2, v0
    v_add_u32 v20, s44, v20
    s_add_u32 s45, s30, 1
    s_and_b32 s45, s45, 3
    s_mul_i32 s45, s45, 4608
    v_add_u32 v21, s45, v19
    v_add_u32 v22, s45, v20
    ds_read_b128 v[80:83], v21
    ds_read_b128 v[84:87], v21 offset:1024
    ds_read_b32 v88, v22 offset:2048
    s_add_u32 s45, s30, 2
    s_and_b32 s45, s45, 3
    s_mul_i32 s45, s45, 4608
    v_add_u32 v21, s45, v19
    v_add_u32 v22, s45, v20
    ds_read_b128 v[90:93], v21
    ds_read_b128 v[94:97], v21 offset:1024
    ds_read_b32 v98, v22 offset:2048
    s_add_u32 s45, s30, 3
    s_and_b32 s45, s45, 3
    s_mul_i32 s45, s45, 4608
    v_add_u32 v21, s45, v19
    v_add_u32 v22, s45, v20
    ds_read_b128 v[100:103], v21
    ds_read_b128 v[104:107], v21 offset:1024
    ds_read_b32 v108, v22 offset:2048
    s_waitcnt lgkmcnt(0)
    v_add_f32 v48, v48, v80
    v_add_f32 v49, v49, v81
    v_add_f32 v50, v50, v82
    v_add_f32 v51, v51, v83
    v_add_f32 v52, v52, v84
    v_add_f32 v53, v53, v85
    v_add_f32 v54, v54, v86
    v_add_f32 v55, v55, v87
    v_add_f32 v56, v56, v88
    v_add_f32 v48, v48, v90
    v_add_f32 v49, v49, v91
    v_add_f32 v50, v50, v92
    v_add_f32 v51, v51, v93
    v_add_f32 v52, v52, v94
    v_add_f32 v53, v53, v95
    v_add_f32 v54, v54, v96
    v_add_f32 v55, v55, v97
    v_add_f32 v56, v56, v98
    v_add_f32 v48, v48, v100
    v_add_f32 v49, v49, v101
    v_add_f32 v50, v50, v102
    v_add_f32 v51, v51, v103
    v_add_f32 v52, v52, v104
    v_add_f32 v53, v53, v105
    v_add_f32 v54, v54, v106
    v_add_f32 v55, v55, v107
    v_add_f32 v56, v56, v108
    v_rcp_f32 v21, v56
    s_nop 0
    v_mul_f32 v48, v48, v21
    v_mul_f32 v49, v49, v21
    v_mul_f32 v50, v50, v21
    v_mul_f32 v51, v51, v21
    v_mul_f32 v52, v52, v21
    v_mul_f32 v53, v53, v21
    v_mul_f32 v54, v54, v21
    v_mul_f32 v55, v55, v21
    v_cvt_pk_bf16_f32 v80, v48, v49
    v_cvt_pk_bf16_f32 v81, v50, v51
    v_cvt_pk_bf16_f32 v82, v52, v53
    v_cvt_pk_bf16_f32 v83, v54, v55
    s_add_u32 s33, s32, s30
    s_lshl_b32 s33, s33, 15
    s_lshl_b32 s34, s27, 10
    s_add_u32 s33, s33, s34
    s_add_u32 s33, s33, 6291456
    buffer_store_dwordx4 v[80:83], v4, s[8:11], s33 offen sc1
k2_kernel_done:
k2_kernel_exit:
    s_endpgm
.globl k3_kernel
.p2align 8
.type k3_kernel,@function
k3_kernel:
    s_cmp_ge_u32 s2, 512
    s_cbranch_scc1 k3_to5
    s_cmp_ge_u32 s2, 256
    s_cbranch_scc1 k3_to4
    s_cmp_ge_u32 s2, 256
    s_cbranch_scc1 k3_kernel_exit
    s_load_dwordx2 s[20:21], s[0:1], 16
    s_load_dwordx2 s[22:23], s[0:1], 0
    s_load_dwordx2 s[24:25], s[0:1], 72
    v_lshrrev_b32 v1, 6, v0
    v_and_b32 v0, 63, v0
    s_nop 0
    v_readfirstlane_b32 s47, v1
    s_and_b32 s26, s47, 3
    s_and_b32 s27, s2, 7
    s_lshr_b32 s28, s2, 3
    s_lshl_b32 s29, s27, 2
    s_and_b32 s30, s28, 3
    s_add_u32 s29, s29, s30
    s_lshr_b32 s30, s28, 2
    s_and_b32 s27, s26, 1
    s_lshr_b32 s28, s26, 1
    s_lshl_b32 s31, s29, 1
    s_add_u32 s31, s31, s27
    v_lshrrev_b32 v30, 5, v0
    v_and_b32 v31, 31, v0
    v_lshlrev_b32 v4, 4, v0
    s_cmp_ge_u32 s47, 4
    s_cbranch_scc1 k3_kernel_loader
    s_lshl_b32 s32, s28, 11
    v_mul_u32_u24 v19, 8, v30
    v_bfe_u32 v20, v0, 2, 2
    v_add_u32 v19, v19, v20
    v_lshlrev_b32 v19, 7, v19
    v_bfe_u32 v21, v0, 4, 1
    v_lshlrev_b32 v21, 1, v21
    v_bfe_u32 v22, v0, 1, 1
    v_add_u32 v21, v21, v22
    v_bfe_u32 v22, v0, 3, 1
    v_lshlrev_b32 v22, 2, v22
    v_xor_b32 v21, v21, v22
    v_lshl_add_u32 v19, v21, 4, v19
    v_and_b32 v21, 1, v0
    v_lshl_add_u32 v19, v21, 3, v19
    v_add_u32 v6, s32, v19
    v_xor_b32 v7, 64, v6
    s_lshl_b32 s33, s26, 10
    s_add_u32 s33, s33, 4096
    v_add_u32 v8, s33, v4
    v_add_u32 v9, 65536, v6
    v_add_u32 v10, 65536, v7
    v_add_u32 v11, 65536, v8
    v_mov_b32 v32, 0
    v_mov_b32 v33, 0
    v_mov_b32 v34, 0
    v_mov_b32 v35, 0
    v_mov_b32 v36, 0
    v_mov_b32 v37, 0
    v_mov_b32 v38, 0
    v_mov_b32 v39, 0
    v_mov_b32 v40, 0
    v_mov_b32 v41, 0
    v_mov_b32 v42, 0
    v_mov_b32 v43, 0
    v_mov_b32 v44, 0
    v_mov_b32 v45, 0
    v_mov_b32 v46, 0
    v_mov_b32 v47, 0
    v_mov_b32 v48, 0
    v_mov_b32 v49, 0
    v_mov_b32 v50, 0
    v_mov_b32 v51, 0
    v_mov_b32 v52, 0
    v_mov_b32 v53, 0
    v_mov_b32 v54, 0
    v_mov_b32 v55, 0
    v_mov_b32 v56, 0
    v_mov_b32 v57, 0
    v_mov_b32 v58, 0
    v_mov_b32 v59, 0
    v_mov_b32 v60, 0
    v_mov_b32 v61, 0
    v_mov_b32 v62, 0
    v_mov_b32 v63, 0
    s_waitcnt lgkmcnt(0)
    s_mov_b32 s8, s24
    s_mov_b32 s9, s25
    s_mov_b32 s10, 33554432
    s_mov_b32 s11, 0x00020000
    s_mov_b32 s12, s24
    s_mov_b32 s13, s25
    s_mov_b32 s14, 33554432
    s_mov_b32 s15, 0x00020000
    s_mov_b32 s16, s22
    s_mov_b32 s17, s23
    s_mov_b32 s18, 2097152
    s_mov_b32 s19, 0x00020000
    s_lshl_b32 s38, s31, 15
    s_lshl_b32 s33, s30, 7
    s_add_u32 s38, s38, s33
    s_lshl_b32 s33, s28, 6
    s_add_u32 s38, s38, s33
    v_lshlrev_b32 v19, 10, v31
    v_lshl_add_u32 v19, v30, 4, v19
    buffer_load_dwordx4 v[64:67], v19, s[16:19], s38 offen
    buffer_load_dwordx4 v[68:71], v19, s[16:19], s38 offen offset:32
    s_barrier
    ds_read_b128 v[88:91], v8 offset:0
    ds_read_b64_tr_b16 v[72:73], v6 offset:0
    ds_read_b64_tr_b16 v[74:75], v6 offset:512
    ds_read_b64_tr_b16 v[76:77], v7 offset:0
    ds_read_b64_tr_b16 v[78:79], v7 offset:512
    s_mov_b32 s48, 0
k3_kernel_14:
    ds_read_b128 v[92:95], v8 offset:8192
    ds_read_b64_tr_b16 v[80:81], v6 offset:8192
    ds_read_b64_tr_b16 v[82:83], v6 offset:8704
    ds_read_b64_tr_b16 v[84:85], v7 offset:8192
    ds_read_b64_tr_b16 v[86:87], v7 offset:8704
    s_waitcnt lgkmcnt(5)
    v_mfma_f32_32x32x16_bf16 v[32:47], v[72:75], v[88:91], v[32:47]
    v_mfma_f32_32x32x16_bf16 v[48:63], v[76:79], v[88:91], v[48:63]
    ds_read_b128 v[88:91], v8 offset:16384
    ds_read_b64_tr_b16 v[72:73], v6 offset:16384
    ds_read_b64_tr_b16 v[74:75], v6 offset:16896
    ds_read_b64_tr_b16 v[76:77], v7 offset:16384
    ds_read_b64_tr_b16 v[78:79], v7 offset:16896
    s_waitcnt lgkmcnt(5)
    v_mfma_f32_32x32x16_bf16 v[32:47], v[80:83], v[92:95], v[32:47]
    v_mfma_f32_32x32x16_bf16 v[48:63], v[84:87], v[92:95], v[48:63]
    ds_read_b128 v[92:95], v8 offset:24576
    ds_read_b64_tr_b16 v[80:81], v6 offset:24576
    ds_read_b64_tr_b16 v[82:83], v6 offset:25088
    ds_read_b64_tr_b16 v[84:85], v7 offset:24576
    ds_read_b64_tr_b16 v[86:87], v7 offset:25088
    s_waitcnt lgkmcnt(5)
    v_mfma_f32_32x32x16_bf16 v[32:47], v[72:75], v[88:91], v[32:47]
    v_mfma_f32_32x32x16_bf16 v[48:63], v[76:79], v[88:91], v[48:63]
    s_waitcnt lgkmcnt(0)
    s_barrier
    ds_read_b128 v[88:91], v8 offset:32768
    ds_read_b64_tr_b16 v[72:73], v6 offset:32768
    ds_read_b64_tr_b16 v[74:75], v6 offset:33280
    ds_read_b64_tr_b16 v[76:77], v7 offset:32768
    ds_read_b64_tr_b16 v[78:79], v7 offset:33280
    v_mfma_f32_32x32x16_bf16 v[32:47], v[80:83], v[92:95], v[32:47]
    v_mfma_f32_32x32x16_bf16 v[48:63], v[84:87], v[92:95], v[48:63]
    ds_read_b128 v[92:95], v8 offset:40960
    ds_read_b64_tr_b16 v[80:81], v6 offset:40960
    ds_read_b64_tr_b16 v[82:83], v6 offset:41472
    ds_read_b64_tr_b16 v[84:85], v7 offset:40960
    ds_read_b64_tr_b16 v[86:87], v7 offset:41472
    s_waitcnt lgkmcnt(5)
    v_mfma_f32_32x32x16_bf16 v[32:47], v[72:75], v[88:91], v[32:47]
    v_mfma_f32_32x32x16_bf16 v[48:63], v[76:79], v[88:91], v[48:63]
    ds_read_b128 v[88:91], v8 offset:49152
    ds_read_b64_tr_b16 v[72:73], v6 offset:49152
    ds_read_b64_tr_b16 v[74:75], v6 offset:49664
    ds_read_b64_tr_b16 v[76:77], v7 offset:49152
    ds_read_b64_tr_b16 v[78:79], v7 offset:49664
    s_waitcnt lgkmcnt(5)
    v_mfma_f32_32x32x16_bf16 v[32:47], v[80:83], v[92:95], v[32:47]
    v_mfma_f32_32x32x16_bf16 v[48:63], v[84:87], v[92:95], v[48:63]
    ds_read_b128 v[92:95], v8 offset:57344
    ds_read_b64_tr_b16 v[80:81], v6 offset:57344
    ds_read_b64_tr_b16 v[82:83], v6 offset:57856
    ds_read_b64_tr_b16 v[84:85], v7 offset:57344
    ds_read_b64_tr_b16 v[86:87], v7 offset:57856
    s_waitcnt lgkmcnt(5)
    v_mfma_f32_32x32x16_bf16 v[32:47], v[72:75], v[88:91], v[32:47]
    v_mfma_f32_32x32x16_bf16 v[48:63], v[76:79], v[88:91], v[48:63]
    s_add_u32 s48, s48, 1
    s_cmp_eq_u32 s48, 2
    s_waitcnt lgkmcnt(0)
    s_cbranch_scc1 k3_kernel_15
    s_barrier
    v_swap_b32 v6, v9
    v_swap_b32 v7, v10
    v_swap_b32 v8, v11
    ds_read_b128 v[88:91], v8 offset:0
    ds_read_b64_tr_b16 v[72:73], v6 offset:0
    ds_read_b64_tr_b16 v[74:75], v6 offset:512
    ds_read_b64_tr_b16 v[76:77], v7 offset:0
    ds_read_b64_tr_b16 v[78:79], v7 offset:512
    v_mfma_f32_32x32x16_bf16 v[32:47], v[80:83], v[92:95], v[32:47]
    v_mfma_f32_32x32x16_bf16 v[48:63], v[84:87], v[92:95], v[48:63]
    s_branch k3_kernel_14
k3_kernel_15:
    v_mfma_f32_32x32x16_bf16 v[32:47], v[80:83], v[92:95], v[32:47]
    v_mfma_f32_32x32x16_bf16 v[48:63], v[84:87], v[92:95], v[48:63]
    s_lshl_b32 s33, s26, 12
    s_add_u32 s33, s33, 131072
    s_xor_b32 s39, s26, 2
    s_lshl_b32 s39, s39, 12
    s_add_u32 s39, s39, 131072
    v_add_u32 v19, s33, v4
    v_add_u32 v20, s39, v4
    s_cmp_eq_u32 s28, 0
    s_nop 7
    s_nop 3
    s_cbranch_scc1 k3_kernel_16
    ds_write_b128 v19, v[32:35] offset:0
    ds_write_b128 v19, v[36:39] offset:1024
    ds_write_b128 v19, v[40:43] offset:2048
    ds_write_b128 v19, v[44:47] offset:3072
    s_nop 1
    v_mov_b32 v32, v48
    v_mov_b32 v33, v49
    v_mov_b32 v34, v50
    v_mov_b32 v35, v51
    v_mov_b32 v36, v52
    v_mov_b32 v37, v53
    v_mov_b32 v38, v54
    v_mov_b32 v39, v55
    v_mov_b32 v40, v56
    v_mov_b32 v41, v57
    v_mov_b32 v42, v58
    v_mov_b32 v43, v59
    v_mov_b32 v44, v60
    v_mov_b32 v45, v61
    v_mov_b32 v46, v62
    v_mov_b32 v47, v63
    s_branch k3_kernel_17
k3_kernel_16:
    ds_write_b128 v19, v[48:51] offset:0
    ds_write_b128 v19, v[52:55] offset:1024
    ds_write_b128 v19, v[56:59] offset:2048
    ds_write_b128 v19, v[60:63] offset:3072
k3_kernel_17:
    s_waitcnt lgkmcnt(0)
    s_barrier
    ds_read_b128 v[48:51], v20 offset:0
    ds_read_b128 v[52:55], v20 offset:1024
    ds_read_b128 v[56:59], v20 offset:2048
    ds_read_b128 v[60:63], v20 offset:3072
    s_waitcnt vmcnt(0)
    v_permlane32_swap_b32 v64, v66
    v_permlane32_swap_b32 v65, v67
    v_permlane32_swap_b32 v68, v70
    v_permlane32_swap_b32 v69, v71
    s_nop 1
    v_lshlrev_b32 v72, 16, v64
    v_and_b32 v73, 0xffff0000, v64
    v_lshlrev_b32 v74, 16, v65
    v_and_b32 v75, 0xffff0000, v65
    v_lshlrev_b32 v76, 16, v66
    v_and_b32 v77, 0xffff0000, v66
    v_lshlrev_b32 v78, 16, v67
    v_and_b32 v79, 0xffff0000, v67
    v_lshlrev_b32 v80, 16, v68
    v_and_b32 v81, 0xffff0000, v68
    v_lshlrev_b32 v82, 16, v69
    v_and_b32 v83, 0xffff0000, v69
    v_lshlrev_b32 v84, 16, v70
    v_and_b32 v85, 0xffff0000, v70
    v_lshlrev_b32 v86, 16, v71
    v_and_b32 v87, 0xffff0000, v71
    v_pk_add_f32 v[32:33], v[32:33], v[72:73]
    v_pk_add_f32 v[34:35], v[34:35], v[74:75]
    v_pk_add_f32 v[36:37], v[36:37], v[76:77]
    v_pk_add_f32 v[38:39], v[38:39], v[78:79]
    v_pk_add_f32 v[40:41], v[40:41], v[80:81]
    v_pk_add_f32 v[42:43], v[42:43], v[82:83]
    v_pk_add_f32 v[44:45], v[44:45], v[84:85]
    v_pk_add_f32 v[46:47], v[46:47], v[86:87]
    s_waitcnt lgkmcnt(0)
    v_pk_add_f32 v[32:33], v[32:33], v[48:49]
    v_pk_add_f32 v[34:35], v[34:35], v[50:51]
    v_pk_add_f32 v[36:37], v[36:37], v[52:53]
    v_pk_add_f32 v[38:39], v[38:39], v[54:55]
    v_pk_add_f32 v[40:41], v[40:41], v[56:57]
    v_pk_add_f32 v[42:43], v[42:43], v[58:59]
    v_pk_add_f32 v[44:45], v[44:45], v[60:61]
    v_pk_add_f32 v[46:47], v[46:47], v[62:63]
    v_cvt_pk_bf16_f32 v64, v32, v33
    v_cvt_pk_bf16_f32 v65, v34, v35
    v_cvt_pk_bf16_f32 v66, v36, v37
    v_cvt_pk_bf16_f32 v67, v38, v39
    v_cvt_pk_bf16_f32 v68, v40, v41
    v_cvt_pk_bf16_f32 v69, v42, v43
    v_cvt_pk_bf16_f32 v70, v44, v45
    v_cvt_pk_bf16_f32 v71, v46, v47
    s_lshl_b32 s38, s31, 15
    s_lshl_b32 s33, s30, 12
    s_add_u32 s38, s38, s33
    s_lshl_b32 s33, s28, 11
    s_add_u32 s38, s38, s33
    s_add_u32 s38, s38, 8388608
    buffer_store_dwordx4 v[64:67], v4, s[12:15], s38 offen sc1
    buffer_store_dwordx4 v[68:71], v4, s[12:15], s38 offen offset:1024 sc1
    s_mov_b32 s40, 0x3f803f80
    v_mov_b32 v12, 0
    v_mov_b32 v14, 0
    v_dot2c_f32_bf16 v12, s40, v64
    v_dot2c_f32_bf16 v14, v64, v64
    v_dot2c_f32_bf16 v12, s40, v65
    v_dot2c_f32_bf16 v14, v65, v65
    v_dot2c_f32_bf16 v12, s40, v66
    v_dot2c_f32_bf16 v14, v66, v66
    v_dot2c_f32_bf16 v12, s40, v67
    v_dot2c_f32_bf16 v14, v67, v67
    v_dot2c_f32_bf16 v12, s40, v68
    v_dot2c_f32_bf16 v14, v68, v68
    v_dot2c_f32_bf16 v12, s40, v69
    v_dot2c_f32_bf16 v14, v69, v69
    v_dot2c_f32_bf16 v12, s40, v70
    v_dot2c_f32_bf16 v14, v70, v70
    v_dot2c_f32_bf16 v12, s40, v71
    v_dot2c_f32_bf16 v14, v71, v71
    s_nop 3
    v_mov_b32 v16, v12
    v_mov_b32 v13, v14
    s_nop 1
    v_permlane32_swap_b32 v12, v16
    v_permlane32_swap_b32 v13, v14
    s_nop 1
    v_add_f32 v12, v12, v16
    v_add_f32 v13, v13, v14
    s_lshl_b32 s33, s30, 1
    s_add_u32 s33, s33, s28
    s_lshl_b32 s33, s33, 14
    s_lshl_b32 s39, s31, 8
    s_add_u32 s33, s33, s39
    s_add_u32 s33, s33, 10485760
    v_lshlrev_b32 v19, 3, v31
    buffer_store_dwordx2 v[12:13], v19, s[12:15], s33 offen sc1
    s_lshr_b32 s38, s31, 2
    s_lshl_b32 s38, s38, 8
    s_add_u32 s38, s38, 17235968
    s_waitcnt vmcnt(0)
    s_barrier
    s_cmp_lg_u32 s47, 0
    s_cbranch_scc1 k3_kernel_18
    s_mov_b64 exec, 1
    v_mov_b32 v3, 1
    buffer_atomic_add v3, off, s[12:15], s38
    s_mov_b64 exec, -1
k3_kernel_18:
    s_branch k3_kernel_exit
k3_kernel_loader:
    v_lshrrev_b32 v19, 3, v0
    v_lshlrev_b32 v19, 10, v19
    v_bfe_u32 v20, v0, 4, 1
    v_lshlrev_b32 v20, 2, v20
    v_and_b32 v21, 7, v0
    v_xor_b32 v21, v21, v20
    v_lshl_add_u32 v1, v21, 4, v19
    s_waitcnt lgkmcnt(0)
    s_mov_b32 s4, s20
    s_mov_b32 s5, s21
    s_mov_b32 s6, 524288
    s_mov_b32 s7, 0x00020000
    s_mov_b32 s8, s24
    s_mov_b32 s9, s25
    s_mov_b32 s10, 33554432
    s_mov_b32 s11, 0x00020000
    s_mul_i32 s34, s28, 262144
    s_lshl_b32 s33, s27, 13
    s_add_u32 s34, s34, s33
    s_lshl_b32 s33, s30, 7
    s_add_u32 s34, s34, s33
    s_lshl_b32 s35, s27, 10
    s_lshl_b32 s33, s28, 11
    s_add_u32 s35, s35, s33
    s_lshl_b32 s32, s26, 10
    s_add_u32 s32, s32, 4096
    s_mul_i32 s36, s31, 32768
    s_mul_i32 s33, s28, 16384
    s_add_u32 s36, s36, s33
    s_add_u32 s36, s36, 6291456
    s_mov_b32 s33, 16384
    s_cmp_lt_u32 s47, 8
    s_cbranch_scc1 k3_kernel_19
    s_mov_b32 s35, s32
    s_mov_b32 s34, s36
    v_mov_b32 v1, v4
    s_mov_b32 s33, 1024
    s_mov_b32 s4, s8
    s_mov_b32 s5, s9
    s_mov_b32 s6, s10
    s_mov_b32 s7, s11
k3_kernel_19:
    s_sub_u32 s34, s34, s33
    s_add_u32 m0, s35, 0
    s_add_u32 s34, s34, s33
    buffer_load_dwordx4 v1, s[4:7], s34 offen lds
    s_add_u32 m0, s35, 8192
    s_add_u32 s34, s34, s33
    buffer_load_dwordx4 v1, s[4:7], s34 offen lds
    s_add_u32 m0, s35, 16384
    s_add_u32 s34, s34, s33
    buffer_load_dwordx4 v1, s[4:7], s34 offen lds
    s_add_u32 m0, s35, 24576
    s_add_u32 s34, s34, s33
    buffer_load_dwordx4 v1, s[4:7], s34 offen lds
    s_add_u32 m0, s35, 32768
    s_add_u32 s34, s34, s33
    buffer_load_dwordx4 v1, s[4:7], s34 offen lds
    s_add_u32 m0, s35, 40960
    s_add_u32 s34, s34, s33
    buffer_load_dwordx4 v1, s[4:7], s34 offen lds
    s_add_u32 m0, s35, 49152
    s_add_u32 s34, s34, s33
    buffer_load_dwordx4 v1, s[4:7], s34 offen lds
    s_add_u32 m0, s35, 57344
    s_add_u32 s34, s34, s33
    buffer_load_dwordx4 v1, s[4:7], s34 offen lds
    s_waitcnt vmcnt(4)
    s_barrier
    s_add_u32 m0, s35, 65536
    s_add_u32 s34, s34, s33
    buffer_load_dwordx4 v1, s[4:7], s34 offen lds
    s_add_u32 m0, s35, 73728
    s_add_u32 s34, s34, s33
    buffer_load_dwordx4 v1, s[4:7], s34 offen lds
    s_add_u32 m0, s35, 81920
    s_add_u32 s34, s34, s33
    buffer_load_dwordx4 v1, s[4:7], s34 offen lds
    s_add_u32 m0, s35, 90112
    s_add_u32 s34, s34, s33
    buffer_load_dwordx4 v1, s[4:7], s34 offen lds
    s_waitcnt vmcnt(4)
    s_barrier
    s_add_u32 m0, s35, 98304
    s_add_u32 s34, s34, s33
    buffer_load_dwordx4 v1, s[4:7], s34 offen lds
    s_add_u32 m0, s35, 106496
    s_add_u32 s34, s34, s33
    buffer_load_dwordx4 v1, s[4:7], s34 offen lds
    s_add_u32 m0, s35, 114688
    s_add_u32 s34, s34, s33
    buffer_load_dwordx4 v1, s[4:7], s34 offen lds
    s_add_u32 m0, s35, 122880
    s_add_u32 s34, s34, s33
    buffer_load_dwordx4 v1, s[4:7], s34 offen lds
    s_waitcnt vmcnt(4)
    s_barrier
    s_waitcnt vmcnt(0)
    s_barrier
    s_barrier
    s_endpgm
k3_kernel_exit:
    s_endpgm
k3_to4:
    s_sub_u32 s2, s2, 256
    s_branch k4_kernel
k3_to5:
    s_sub_u32 s2, s2, 512
    s_branch k5_kernel
k4_kernel:
    s_cmp_ge_u32 s2, 240
    s_cbranch_scc1 k4_kernel_exit
    s_load_dwordx4 s[20:23], s[0:1], 32
    s_load_dwordx2 s[24:25], s[0:1], 72
    v_lshrrev_b32 v1, 6, v0
    v_and_b32 v0, 63, v0
    s_nop 0
    v_readfirstlane_b32 s47, v1
    s_and_b32 s26, s47, 3
    s_and_b32 s27, s2, 7
    s_lshr_b32 s28, s2, 3
    s_lshl_b32 s29, s27, 1
    s_and_b32 s30, s28, 1
    s_add_u32 s29, s29, s30
    s_lshr_b32 s30, s28, 1
    s_lshl_b32 s31, s29, 2
    s_add_u32 s31, s31, s26
    v_lshrrev_b32 v30, 5, v0
    v_and_b32 v31, 31, v0
    s_lshl_b32 s32, s26, 12
    s_add_u32 s32, s32, 12288
    v_lshlrev_b32 v20, 4, v0
    v_add_u32 v6, s32, v20
    v_add_u32 v7, 1024, v6
    v_add_u32 v8, 2048, v6
    v_add_u32 v9, 3072, v6
    v_mul_u32_u24 v19, 4, v30
    v_bfe_u32 v20, v0, 2, 2
    v_add_u32 v19, v19, v20
    v_mul_u32_u24 v19, 192, v19
    v_bfe_u32 v20, v0, 4, 1
    v_lshl_add_u32 v19, v20, 5, v19
    v_and_b32 v20, 3, v0
    v_lshl_add_u32 v10, v20, 3, v19
    v_lshlrev_b32 v4, 4, v0
    s_cmp_ge_u32 s47, 4
    s_cbranch_scc1 k4_kernel_loader
    v_mov_b32 v64, 0
    v_mov_b32 v65, 0
    v_mov_b32 v66, 0
    v_mov_b32 v67, 0
    v_mov_b32 v68, 0
    v_mov_b32 v69, 0
    v_mov_b32 v70, 0
    v_mov_b32 v71, 0
    v_mov_b32 v72, 0
    v_mov_b32 v73, 0
    v_mov_b32 v74, 0
    v_mov_b32 v75, 0
    v_mov_b32 v76, 0
    v_mov_b32 v77, 0
    v_mov_b32 v78, 0
    v_mov_b32 v79, 0
    v_mov_b32 v80, 0
    v_mov_b32 v81, 0
    v_mov_b32 v82, 0
    v_mov_b32 v83, 0
    v_mov_b32 v84, 0
    v_mov_b32 v85, 0
    v_mov_b32 v86, 0
    v_mov_b32 v87, 0
    v_mov_b32 v88, 0
    v_mov_b32 v89, 0
    v_mov_b32 v90, 0
    v_mov_b32 v91, 0
    v_mov_b32 v92, 0
    v_mov_b32 v93, 0
    v_mov_b32 v94, 0
    v_mov_b32 v95, 0
    v_mov_b32 v96, 0
    v_mov_b32 v97, 0
    v_mov_b32 v98, 0
    v_mov_b32 v99, 0
    v_mov_b32 v100, 0
    v_mov_b32 v101, 0
    v_mov_b32 v102, 0
    v_mov_b32 v103, 0
    v_mov_b32 v104, 0
    v_mov_b32 v105, 0
    v_mov_b32 v106, 0
    v_mov_b32 v107, 0
    v_mov_b32 v108, 0
    v_mov_b32 v109, 0
    v_mov_b32 v110, 0
    v_mov_b32 v111, 0
    s_waitcnt lgkmcnt(0)
    s_mov_b32 s12, s24
    s_mov_b32 s13, s25
    s_mov_b32 s14, 33554432
    s_mov_b32 s15, 0x00020000
    s_mov_b32 s16, s22
    s_mov_b32 s17, s23
    s_mov_b32 s18, 2752
    s_mov_b32 s19, 0x00020000
    s_barrier
    s_lshl_b32 s37, s31, 8
    s_add_u32 s37, s37, 10485760
    v_lshlrev_b32 v19, 17, v30
    v_lshl_add_u32 v19, v31, 3, v19
    s_add_u32 s33, s37, 0
    buffer_load_dwordx2 v[120:121], v19, s[12:15], s33 offen
    s_add_u32 s33, s37, 16384
    buffer_load_dwordx2 v[122:123], v19, s[12:15], s33 offen
    s_add_u32 s33, s37, 32768
    buffer_load_dwordx2 v[124:125], v19, s[12:15], s33 offen
    s_add_u32 s33, s37, 49152
    buffer_load_dwordx2 v[126:127], v19, s[12:15], s33 offen
    s_add_u32 s33, s37, 65536
    buffer_load_dwordx2 v[128:129], v19, s[12:15], s33 offen
    s_add_u32 s33, s37, 81920
    buffer_load_dwordx2 v[130:131], v19, s[12:15], s33 offen
    s_add_u32 s33, s37, 98304
    buffer_load_dwordx2 v[132:133], v19, s[12:15], s33 offen
    s_add_u32 s33, s37, 114688
    buffer_load_dwordx2 v[134:135], v19, s[12:15], s33 offen
    s_mul_i32 s37, s30, 96
    v_add_u32 v19, s37, v0
    v_lshlrev_b32 v19, 1, v19
    buffer_load_ushort v28, v19, s[16:19], 0 offen
    v_add_u32 v19, 64, v31
    v_add_u32 v19, s37, v19
    v_lshlrev_b32 v19, 1, v19
    buffer_load_ushort v29, v19, s[16:19], 0 offen
    s_barrier
    ds_read_b128 v[112:115], v6
    ds_read_b64_tr_b16 v[40:41], v10 offset:0
    ds_read_b64_tr_b16 v[42:43], v10 offset:1536
    ds_read_b64_tr_b16 v[44:45], v10 offset:64
    ds_read_b64_tr_b16 v[46:47], v10 offset:1600
    ds_read_b64_tr_b16 v[48:49], v10 offset:128
    ds_read_b64_tr_b16 v[50:51], v10 offset:1664
    s_mov_b32 s48, 0
k4_kernel_20:
    ds_read_b128 v[116:119], v7
    ds_read_b64_tr_b16 v[52:53], v10 offset:3072
    ds_read_b64_tr_b16 v[54:55], v10 offset:4608
    ds_read_b64_tr_b16 v[56:57], v10 offset:3136
    ds_read_b64_tr_b16 v[58:59], v10 offset:4672
    ds_read_b64_tr_b16 v[60:61], v10 offset:3200
    ds_read_b64_tr_b16 v[62:63], v10 offset:4736
    s_waitcnt lgkmcnt(7)
    v_mfma_f32_32x32x16_bf16 v[64:79], v[40:43], v[112:115], v[64:79]
    v_mfma_f32_32x32x16_bf16 v[80:95], v[44:47], v[112:115], v[80:95]
    v_mfma_f32_32x32x16_bf16 v[96:111], v[48:51], v[112:115], v[96:111]
    ds_read_b128 v[112:115], v8
    ds_read_b64_tr_b16 v[40:41], v10 offset:6144
    ds_read_b64_tr_b16 v[42:43], v10 offset:7680
    ds_read_b64_tr_b16 v[44:45], v10 offset:6208
    ds_read_b64_tr_b16 v[46:47], v10 offset:7744
    ds_read_b64_tr_b16 v[48:49], v10 offset:6272
    ds_read_b64_tr_b16 v[50:51], v10 offset:7808
    s_waitcnt lgkmcnt(7)
    v_mfma_f32_32x32x16_bf16 v[64:79], v[52:55], v[116:119], v[64:79]
    v_mfma_f32_32x32x16_bf16 v[80:95], v[56:59], v[116:119], v[80:95]
    v_mfma_f32_32x32x16_bf16 v[96:111], v[60:63], v[116:119], v[96:111]
    s_cmp_lg_u32 s48, 4
    s_cbranch_scc1 k4_kernel_22
    s_waitcnt vmcnt(0)
    v_pk_add_f32 v[120:121], v[120:121], v[122:123]
    v_pk_add_f32 v[120:121], v[120:121], v[124:125]
    v_pk_add_f32 v[120:121], v[120:121], v[126:127]
    v_pk_add_f32 v[120:121], v[120:121], v[128:129]
    v_pk_add_f32 v[120:121], v[120:121], v[130:131]
    v_pk_add_f32 v[120:121], v[120:121], v[132:133]
    v_pk_add_f32 v[120:121], v[120:121], v[134:135]
    v_mov_b32 v12, v120
    v_mov_b32 v13, v120
    v_mov_b32 v14, v121
    v_mov_b32 v15, v121
    s_nop 1
    v_permlane32_swap_b32 v12, v13
    v_permlane32_swap_b32 v14, v15
    s_nop 1
    v_add_f32 v12, v12, v13
    v_add_f32 v14, v14, v15
    v_mul_f32 v12, 0x3b000000, v12
    v_mul_f32 v14, 0x3b000000, v14
    v_fma_f32 v14, -v12, v12, v14
    v_max_f32 v14, 0, v14
    v_add_f32 v14, 0x3727c5ac, v14
    v_rsq_f32 v13, v14
    s_nop 0
    v_mul_f32 v12, v12, v13
    v_sub_f32 v12, 0, v12
k4_kernel_22:
    ds_read_b128 v[116:119], v9
    ds_read_b64_tr_b16 v[52:53], v10 offset:9216
    ds_read_b64_tr_b16 v[54:55], v10 offset:10752
    ds_read_b64_tr_b16 v[56:57], v10 offset:9280
    ds_read_b64_tr_b16 v[58:59], v10 offset:10816
    ds_read_b64_tr_b16 v[60:61], v10 offset:9344
    ds_read_b64_tr_b16 v[62:63], v10 offset:10880
    s_waitcnt lgkmcnt(7)
    v_mfma_f32_32x32x16_bf16 v[64:79], v[40:43], v[112:115], v[64:79]
    v_mfma_f32_32x32x16_bf16 v[80:95], v[44:47], v[112:115], v[80:95]
    v_mfma_f32_32x32x16_bf16 v[96:111], v[48:51], v[112:115], v[96:111]
    s_mov_b32 s49, 28672
    s_cmp_eq_u32 s48, 4
    s_cselect_b32 s49, 0xfffe4000, s49
    s_cmp_eq_u32 s48, 7
    s_waitcnt lgkmcnt(0)
    s_cbranch_scc1 k4_kernel_21
    s_barrier
    v_add_u32 v6, s49, v6
    v_add_u32 v7, s49, v7
    v_add_u32 v8, s49, v8
    v_add_u32 v9, s49, v9
    v_add_u32 v10, s49, v10
    ds_read_b128 v[112:115], v6
    ds_read_b64_tr_b16 v[40:41], v10 offset:0
    ds_read_b64_tr_b16 v[42:43], v10 offset:1536
    ds_read_b64_tr_b16 v[44:45], v10 offset:64
    ds_read_b64_tr_b16 v[46:47], v10 offset:1600
    ds_read_b64_tr_b16 v[48:49], v10 offset:128
    ds_read_b64_tr_b16 v[50:51], v10 offset:1664
    v_mfma_f32_32x32x16_bf16 v[64:79], v[52:55], v[116:119], v[64:79]
    v_mfma_f32_32x32x16_bf16 v[80:95], v[56:59], v[116:119], v[80:95]
    v_mfma_f32_32x32x16_bf16 v[96:111], v[60:63], v[116:119], v[96:111]
    s_add_u32 s48, s48, 1
    s_branch k4_kernel_20
k4_kernel_21:
    v_mfma_f32_32x32x16_bf16 v[64:79], v[52:55], v[116:119], v[64:79]
    v_mfma_f32_32x32x16_bf16 v[80:95], v[56:59], v[116:119], v[80:95]
    v_mfma_f32_32x32x16_bf16 v[96:111], v[60:63], v[116:119], v[96:111]
    s_waitcnt vmcnt(0)
    s_barrier
    v_lshlrev_b32 v19, 2, v0
    v_add_u32 v19, 143360, v19
    v_lshlrev_b32 v20, 2, v31
    v_add_u32 v20, 143616, v20
    ds_read_b32 v112, v19 offset:0
    ds_read_b32 v120, v20 offset:0
    ds_read_b32 v113, v19 offset:384
    ds_read_b32 v121, v20 offset:384
    ds_read_b32 v114, v19 offset:768
    ds_read_b32 v122, v20 offset:768
    ds_read_b32 v115, v19 offset:1152
    ds_read_b32 v123, v20 offset:1152
    ds_read_b32 v116, v19 offset:1536
    ds_read_b32 v124, v20 offset:1536
    ds_read_b32 v117, v19 offset:1920
    ds_read_b32 v125, v20 offset:1920
    ds_read_b32 v118, v19 offset:2304
    ds_read_b32 v126, v20 offset:2304
    ds_read_b32 v119, v19 offset:2688
    ds_read_b32 v127, v20 offset:2688
    s_waitcnt lgkmcnt(0)
    v_add_f32 v112, v112, v113
    v_add_f32 v120, v120, v121
    v_add_f32 v112, v112, v114
    v_add_f32 v120, v120, v122
    v_add_f32 v112, v112, v115
    v_add_f32 v120, v120, v123
    v_add_f32 v112, v112, v116
    v_add_f32 v120, v120, v124
    v_add_f32 v112, v112, v117
    v_add_f32 v120, v120, v125
    v_add_f32 v112, v112, v118
    v_add_f32 v120, v120, v126
    v_add_f32 v112, v112, v119
    v_add_f32 v120, v120, v127
    s_lshl_b32 s32, s26, 10
    s_add_u32 s32, s32, 147456
    v_lshlrev_b32 v19, 2, v0
    v_add_u32 v19, s32, v19
    v_lshlrev_b32 v20, 2, v31
    v_add_u32 v20, s32, v20
    v_mul_f32 v112, 0x3fb8aa3b, v112
    v_mul_f32 v120, 0x3fb8aa3b, v120
    v_lshlrev_b32 v28, 16, v28
    v_lshlrev_b32 v29, 16, v29
    v_mul_f32 v28, 0x3fb8aa3b, v28
    v_mul_f32 v29, 0x3fb8aa3b, v29
    ds_write_b32 v19, v28 offset:512
    ds_write_b32 v20, v29 offset:768
    ds_write_b32 v19, v112
    ds_write_b32 v20, v120 offset:256
    v_lshlrev_b32 v19, 4, v30
    v_add_u32 v19, s32, v19
    s_waitcnt lgkmcnt(0)
    ds_read_b128 v[112:115], v19 offset:0
    ds_read_b128 v[116:119], v19 offset:32
    ds_read_b128 v[120:123], v19 offset:64
    ds_read_b128 v[124:127], v19 offset:96
    ds_read_b128 v[128:131], v19 offset:128
    ds_read_b128 v[132:135], v19 offset:160
    ds_read_b128 v[136:139], v19 offset:192
    ds_read_b128 v[140:143], v19 offset:224
    ds_read_b128 v[144:147], v19 offset:256
    ds_read_b128 v[148:151], v19 offset:288
    ds_read_b128 v[152:155], v19 offset:320
    ds_read_b128 v[156:159], v19 offset:352
    s_waitcnt lgkmcnt(4)
    ds_read_b128 v[40:43], v19 offset:512
    ds_read_b128 v[44:47], v19 offset:544
    ds_read_b128 v[48:51], v19 offset:576
    ds_read_b128 v[52:55], v19 offset:608
    ds_read_b128 v[56:59], v19 offset:640
    ds_read_b128 v[60:63], v19 offset:672
    ds_read_b128 v[160:163], v19 offset:704
    ds_read_b128 v[164:167], v19 offset:736
    v_mov_b32 v26, 0x3f317218
    s_mov_b32 s44, 0xbfb17218
    s_mov_b32 s45, 0xbfb17218
    s_mul_i32 s38, s31, 88064
    s_add_u32 s38, s38, 11534336
    s_mul_i32 s39, s30, 3
    s_waitcnt lgkmcnt(0)
    v_mul_f32 v20, 0x3fb8aa3b, v13
    v_mov_b32 v22, v12
    s_add_u32 s40, s39, 0
    s_cmp_ge_u32 s40, 43
    s_cbranch_scc1 k4_kernel_fin
    s_lshl_b32 s40, s40, 11
    s_add_u32 s42, s40, s38
    v_pk_fma_f32 v[112:113], v[112:113], v[22:23], v[40:41] op_sel_hi:[1,0,1]
    v_pk_fma_f32 v[114:115], v[114:115], v[22:23], v[42:43] op_sel_hi:[1,0,1]
    v_pk_fma_f32 v[116:117], v[116:117], v[22:23], v[44:45] op_sel_hi:[1,0,1]
    v_pk_fma_f32 v[118:119], v[118:119], v[22:23], v[46:47] op_sel_hi:[1,0,1]
    v_pk_fma_f32 v[120:121], v[120:121], v[22:23], v[48:49] op_sel_hi:[1,0,1]
    v_pk_fma_f32 v[122:123], v[122:123], v[22:23], v[50:51] op_sel_hi:[1,0,1]
    v_pk_fma_f32 v[124:125], v[124:125], v[22:23], v[52:53] op_sel_hi:[1,0,1]
    v_pk_fma_f32 v[126:127], v[126:127], v[22:23], v[54:55] op_sel_hi:[1,0,1]
    v_pk_fma_f32 v[64:65], v[64:65], v[20:21], v[112:113] op_sel_hi:[1,0,1]
    v_pk_fma_f32 v[66:67], v[66:67], v[20:21], v[114:115] op_sel_hi:[1,0,1]
    v_pk_fma_f32 v[68:69], v[68:69], v[20:21], v[116:117] op_sel_hi:[1,0,1]
    v_pk_fma_f32 v[70:71], v[70:71], v[20:21], v[118:119] op_sel_hi:[1,0,1]
    v_pk_fma_f32 v[72:73], v[72:73], v[20:21], v[120:121] op_sel_hi:[1,0,1]
    v_pk_fma_f32 v[74:75], v[74:75], v[20:21], v[122:123] op_sel_hi:[1,0,1]
    v_pk_fma_f32 v[76:77], v[76:77], v[20:21], v[124:125] op_sel_hi:[1,0,1]
    v_pk_fma_f32 v[78:79], v[78:79], v[20:21], v[126:127] op_sel_hi:[1,0,1]
    v_exp_f32 v112, v64
    v_exp_f32 v113, v65
    v_exp_f32 v114, v66
    v_exp_f32 v115, v67
    v_exp_f32 v116, v68
    v_exp_f32 v117, v69
    v_exp_f32 v118, v70
    v_exp_f32 v119, v71
    v_exp_f32 v120, v72
    v_exp_f32 v121, v73
    v_exp_f32 v122, v74
    v_exp_f32 v123, v75
    v_exp_f32 v124, v76
    v_exp_f32 v125, v77
    v_exp_f32 v126, v78
    v_exp_f32 v127, v79
    v_pk_add_f32 v[112:113], v[112:113], 1.0 op_sel_hi:[1,0]
    v_pk_add_f32 v[114:115], v[114:115], 1.0 op_sel_hi:[1,0]
    v_pk_add_f32 v[116:117], v[116:117], 1.0 op_sel_hi:[1,0]
    v_pk_add_f32 v[118:119], v[118:119], 1.0 op_sel_hi:[1,0]
    v_pk_add_f32 v[120:121], v[120:121], 1.0 op_sel_hi:[1,0]
    v_pk_add_f32 v[122:123], v[122:123], 1.0 op_sel_hi:[1,0]
    v_pk_add_f32 v[124:125], v[124:125], 1.0 op_sel_hi:[1,0]
    v_pk_add_f32 v[126:127], v[126:127], 1.0 op_sel_hi:[1,0]
    v_pk_fma_f32 v[112:113], v[112:113], v[112:113], 1.0 op_sel_hi:[1,1,0]
    v_pk_fma_f32 v[114:115], v[114:115], v[114:115], 1.0 op_sel_hi:[1,1,0]
    v_pk_fma_f32 v[116:117], v[116:117], v[116:117], 1.0 op_sel_hi:[1,1,0]
    v_pk_fma_f32 v[118:119], v[118:119], v[118:119], 1.0 op_sel_hi:[1,1,0]
    v_pk_fma_f32 v[120:121], v[120:121], v[120:121], 1.0 op_sel_hi:[1,1,0]
    v_pk_fma_f32 v[122:123], v[122:123], v[122:123], 1.0 op_sel_hi:[1,1,0]
    v_pk_fma_f32 v[124:125], v[124:125], v[124:125], 1.0 op_sel_hi:[1,1,0]
    v_pk_fma_f32 v[126:127], v[126:127], v[126:127], 1.0 op_sel_hi:[1,1,0]
    v_rcp_f32 v112, v112
    v_rcp_f32 v113, v113
    v_rcp_f32 v114, v114
    v_rcp_f32 v115, v115
    v_rcp_f32 v116, v116
    v_rcp_f32 v117, v117
    v_rcp_f32 v118, v118
    v_rcp_f32 v119, v119
    v_rcp_f32 v120, v120
    v_rcp_f32 v121, v121
    v_rcp_f32 v122, v122
    v_rcp_f32 v123, v123
    v_rcp_f32 v124, v124
    v_rcp_f32 v125, v125
    v_rcp_f32 v126, v126
    v_rcp_f32 v127, v127
    v_pk_fma_f32 v[112:113], v[112:113], s[44:45], v[26:27] op_sel_hi:[1,0,0]
    v_pk_fma_f32 v[114:115], v[114:115], s[44:45], v[26:27] op_sel_hi:[1,0,0]
    v_pk_fma_f32 v[116:117], v[116:117], s[44:45], v[26:27] op_sel_hi:[1,0,0]
    v_pk_fma_f32 v[118:119], v[118:119], s[44:45], v[26:27] op_sel_hi:[1,0,0]
    v_pk_fma_f32 v[120:121], v[120:121], s[44:45], v[26:27] op_sel_hi:[1,0,0]
    v_pk_fma_f32 v[122:123], v[122:123], s[44:45], v[26:27] op_sel_hi:[1,0,0]
    v_pk_fma_f32 v[124:125], v[124:125], s[44:45], v[26:27] op_sel_hi:[1,0,0]
    v_pk_fma_f32 v[126:127], v[126:127], s[44:45], v[26:27] op_sel_hi:[1,0,0]
    v_pk_mul_f32 v[64:65], v[64:65], v[112:113]
    v_pk_mul_f32 v[66:67], v[66:67], v[114:115]
    v_pk_mul_f32 v[68:69], v[68:69], v[116:117]
    v_pk_mul_f32 v[70:71], v[70:71], v[118:119]
    v_pk_mul_f32 v[72:73], v[72:73], v[120:121]
    v_pk_mul_f32 v[74:75], v[74:75], v[122:123]
    v_pk_mul_f32 v[76:77], v[76:77], v[124:125]
    v_pk_mul_f32 v[78:79], v[78:79], v[126:127]
    v_cvt_pk_bf16_f32 v112, v64, v65
    v_cvt_pk_bf16_f32 v113, v66, v67
    v_cvt_pk_bf16_f32 v114, v68, v69
    v_cvt_pk_bf16_f32 v115, v70, v71
    v_cvt_pk_bf16_f32 v116, v72, v73
    v_cvt_pk_bf16_f32 v117, v74, v75
    v_cvt_pk_bf16_f32 v118, v76, v77
    v_cvt_pk_bf16_f32 v119, v78, v79
    ds_read_b128 v[64:67], v19 offset:768
    ds_read_b128 v[68:71], v19 offset:800
    ds_read_b128 v[72:75], v19 offset:832
    ds_read_b128 v[76:79], v19 offset:864
    buffer_store_dwordx4 v[112:115], v4, s[12:15], s42 offen sc1
    buffer_store_dwordx4 v[116:119], v4, s[12:15], s42 offen offset:1024 sc1
    s_add_u32 s40, s39, 1
    s_cmp_ge_u32 s40, 43
    s_cbranch_scc1 k4_kernel_fin
    s_lshl_b32 s40, s40, 11
    s_add_u32 s42, s40, s38
    v_pk_fma_f32 v[128:129], v[128:129], v[22:23], v[56:57] op_sel_hi:[1,0,1]
    v_pk_fma_f32 v[130:131], v[130:131], v[22:23], v[58:59] op_sel_hi:[1,0,1]
    v_pk_fma_f32 v[132:133], v[132:133], v[22:23], v[60:61] op_sel_hi:[1,0,1]
    v_pk_fma_f32 v[134:135], v[134:135], v[22:23], v[62:63] op_sel_hi:[1,0,1]
    v_pk_fma_f32 v[136:137], v[136:137], v[22:23], v[160:161] op_sel_hi:[1,0,1]
    v_pk_fma_f32 v[138:139], v[138:139], v[22:23], v[162:163] op_sel_hi:[1,0,1]
    v_pk_fma_f32 v[140:141], v[140:141], v[22:23], v[164:165] op_sel_hi:[1,0,1]
    v_pk_fma_f32 v[142:143], v[142:143], v[22:23], v[166:167] op_sel_hi:[1,0,1]
    v_pk_fma_f32 v[80:81], v[80:81], v[20:21], v[128:129] op_sel_hi:[1,0,1]
    v_pk_fma_f32 v[82:83], v[82:83], v[20:21], v[130:131] op_sel_hi:[1,0,1]
    v_pk_fma_f32 v[84:85], v[84:85], v[20:21], v[132:133] op_sel_hi:[1,0,1]
    v_pk_fma_f32 v[86:87], v[86:87], v[20:21], v[134:135] op_sel_hi:[1,0,1]
    v_pk_fma_f32 v[88:89], v[88:89], v[20:21], v[136:137] op_sel_hi:[1,0,1]
    v_pk_fma_f32 v[90:91], v[90:91], v[20:21], v[138:139] op_sel_hi:[1,0,1]
    v_pk_fma_f32 v[92:93], v[92:93], v[20:21], v[140:141] op_sel_hi:[1,0,1]
    v_pk_fma_f32 v[94:95], v[94:95], v[20:21], v[142:143] op_sel_hi:[1,0,1]
    v_exp_f32 v128, v80
    v_exp_f32 v129, v81
    v_exp_f32 v130, v82
    v_exp_f32 v131, v83
    v_exp_f32 v132, v84
    v_exp_f32 v133, v85
    v_exp_f32 v134, v86
    v_exp_f32 v135, v87
    v_exp_f32 v136, v88
    v_exp_f32 v137, v89
    v_exp_f32 v138, v90
    v_exp_f32 v139, v91
    v_exp_f32 v140, v92
    v_exp_f32 v141, v93
    v_exp_f32 v142, v94
    v_exp_f32 v143, v95
    v_pk_add_f32 v[128:129], v[128:129], 1.0 op_sel_hi:[1,0]
    v_pk_add_f32 v[130:131], v[130:131], 1.0 op_sel_hi:[1,0]
    v_pk_add_f32 v[132:133], v[132:133], 1.0 op_sel_hi:[1,0]
    v_pk_add_f32 v[134:135], v[134:135], 1.0 op_sel_hi:[1,0]
    v_pk_add_f32 v[136:137], v[136:137], 1.0 op_sel_hi:[1,0]
    v_pk_add_f32 v[138:139], v[138:139], 1.0 op_sel_hi:[1,0]
    v_pk_add_f32 v[140:141], v[140:141], 1.0 op_sel_hi:[1,0]
    v_pk_add_f32 v[142:143], v[142:143], 1.0 op_sel_hi:[1,0]
    v_pk_fma_f32 v[128:129], v[128:129], v[128:129], 1.0 op_sel_hi:[1,1,0]
    v_pk_fma_f32 v[130:131], v[130:131], v[130:131], 1.0 op_sel_hi:[1,1,0]
    v_pk_fma_f32 v[132:133], v[132:133], v[132:133], 1.0 op_sel_hi:[1,1,0]
    v_pk_fma_f32 v[134:135], v[134:135], v[134:135], 1.0 op_sel_hi:[1,1,0]
    v_pk_fma_f32 v[136:137], v[136:137], v[136:137], 1.0 op_sel_hi:[1,1,0]
    v_pk_fma_f32 v[138:139], v[138:139], v[138:139], 1.0 op_sel_hi:[1,1,0]
    v_pk_fma_f32 v[140:141], v[140:141], v[140:141], 1.0 op_sel_hi:[1,1,0]
    v_pk_fma_f32 v[142:143], v[142:143], v[142:143], 1.0 op_sel_hi:[1,1,0]
    v_rcp_f32 v128, v128
    v_rcp_f32 v129, v129
    v_rcp_f32 v130, v130
    v_rcp_f32 v131, v131
    v_rcp_f32 v132, v132
    v_rcp_f32 v133, v133
    v_rcp_f32 v134, v134
    v_rcp_f32 v135, v135
    v_rcp_f32 v136, v136
    v_rcp_f32 v137, v137
    v_rcp_f32 v138, v138
    v_rcp_f32 v139, v139
    v_rcp_f32 v140, v140
    v_rcp_f32 v141, v141
    v_rcp_f32 v142, v142
    v_rcp_f32 v143, v143
    v_pk_fma_f32 v[128:129], v[128:129], s[44:45], v[26:27] op_sel_hi:[1,0,0]
    v_pk_fma_f32 v[130:131], v[130:131], s[44:45], v[26:27] op_sel_hi:[1,0,0]
    v_pk_fma_f32 v[132:133], v[132:133], s[44:45], v[26:27] op_sel_hi:[1,0,0]
    v_pk_fma_f32 v[134:135], v[134:135], s[44:45], v[26:27] op_sel_hi:[1,0,0]
    v_pk_fma_f32 v[136:137], v[136:137], s[44:45], v[26:27] op_sel_hi:[1,0,0]
    v_pk_fma_f32 v[138:139], v[138:139], s[44:45], v[26:27] op_sel_hi:[1,0,0]
    v_pk_fma_f32 v[140:141], v[140:141], s[44:45], v[26:27] op_sel_hi:[1,0,0]
    v_pk_fma_f32 v[142:143], v[142:143], s[44:45], v[26:27] op_sel_hi:[1,0,0]
    v_pk_mul_f32 v[80:81], v[80:81], v[128:129]
    v_pk_mul_f32 v[82:83], v[82:83], v[130:131]
    v_pk_mul_f32 v[84:85], v[84:85], v[132:133]
    v_pk_mul_f32 v[86:87], v[86:87], v[134:135]
    v_pk_mul_f32 v[88:89], v[88:89], v[136:137]
    v_pk_mul_f32 v[90:91], v[90:91], v[138:139]
    v_pk_mul_f32 v[92:93], v[92:93], v[140:141]
    v_pk_mul_f32 v[94:95], v[94:95], v[142:143]
    v_cvt_pk_bf16_f32 v128, v80, v81
    v_cvt_pk_bf16_f32 v129, v82, v83
    v_cvt_pk_bf16_f32 v130, v84, v85
    v_cvt_pk_bf16_f32 v131, v86, v87
    v_cvt_pk_bf16_f32 v132, v88, v89
    v_cvt_pk_bf16_f32 v133, v90, v91
    v_cvt_pk_bf16_f32 v134, v92, v93
    v_cvt_pk_bf16_f32 v135, v94, v95
    buffer_store_dwordx4 v[128:131], v4, s[12:15], s42 offen sc1
    buffer_store_dwordx4 v[132:135], v4, s[12:15], s42 offen offset:1024 sc1
    s_add_u32 s40, s39, 2
    s_cmp_ge_u32 s40, 43
    s_cbranch_scc1 k4_kernel_fin
    s_lshl_b32 s40, s40, 11
    s_add_u32 s42, s40, s38
    s_waitcnt lgkmcnt(0)
    v_pk_fma_f32 v[144:145], v[144:145], v[22:23], v[64:65] op_sel_hi:[1,0,1]
    v_pk_fma_f32 v[146:147], v[146:147], v[22:23], v[66:67] op_sel_hi:[1,0,1]
    v_pk_fma_f32 v[148:149], v[148:149], v[22:23], v[68:69] op_sel_hi:[1,0,1]
    v_pk_fma_f32 v[150:151], v[150:151], v[22:23], v[70:71] op_sel_hi:[1,0,1]
    v_pk_fma_f32 v[152:153], v[152:153], v[22:23], v[72:73] op_sel_hi:[1,0,1]
    v_pk_fma_f32 v[154:155], v[154:155], v[22:23], v[74:75] op_sel_hi:[1,0,1]
    v_pk_fma_f32 v[156:157], v[156:157], v[22:23], v[76:77] op_sel_hi:[1,0,1]
    v_pk_fma_f32 v[158:159], v[158:159], v[22:23], v[78:79] op_sel_hi:[1,0,1]
    v_pk_fma_f32 v[96:97], v[96:97], v[20:21], v[144:145] op_sel_hi:[1,0,1]
    v_pk_fma_f32 v[98:99], v[98:99], v[20:21], v[146:147] op_sel_hi:[1,0,1]
    v_pk_fma_f32 v[100:101], v[100:101], v[20:21], v[148:149] op_sel_hi:[1,0,1]
    v_pk_fma_f32 v[102:103], v[102:103], v[20:21], v[150:151] op_sel_hi:[1,0,1]
    v_pk_fma_f32 v[104:105], v[104:105], v[20:21], v[152:153] op_sel_hi:[1,0,1]
    v_pk_fma_f32 v[106:107], v[106:107], v[20:21], v[154:155] op_sel_hi:[1,0,1]
    v_pk_fma_f32 v[108:109], v[108:109], v[20:21], v[156:157] op_sel_hi:[1,0,1]
    v_pk_fma_f32 v[110:111], v[110:111], v[20:21], v[158:159] op_sel_hi:[1,0,1]
    v_exp_f32 v144, v96
    v_exp_f32 v145, v97
    v_exp_f32 v146, v98
    v_exp_f32 v147, v99
    v_exp_f32 v148, v100
    v_exp_f32 v149, v101
    v_exp_f32 v150, v102
    v_exp_f32 v151, v103
    v_exp_f32 v152, v104
    v_exp_f32 v153, v105
    v_exp_f32 v154, v106
    v_exp_f32 v155, v107
    v_exp_f32 v156, v108
    v_exp_f32 v157, v109
    v_exp_f32 v158, v110
    v_exp_f32 v159, v111
    v_pk_add_f32 v[144:145], v[144:145], 1.0 op_sel_hi:[1,0]
    v_pk_add_f32 v[146:147], v[146:147], 1.0 op_sel_hi:[1,0]
    v_pk_add_f32 v[148:149], v[148:149], 1.0 op_sel_hi:[1,0]
    v_pk_add_f32 v[150:151], v[150:151], 1.0 op_sel_hi:[1,0]
    v_pk_add_f32 v[152:153], v[152:153], 1.0 op_sel_hi:[1,0]
    v_pk_add_f32 v[154:155], v[154:155], 1.0 op_sel_hi:[1,0]
    v_pk_add_f32 v[156:157], v[156:157], 1.0 op_sel_hi:[1,0]
    v_pk_add_f32 v[158:159], v[158:159], 1.0 op_sel_hi:[1,0]
    v_pk_fma_f32 v[144:145], v[144:145], v[144:145], 1.0 op_sel_hi:[1,1,0]
    v_pk_fma_f32 v[146:147], v[146:147], v[146:147], 1.0 op_sel_hi:[1,1,0]
    v_pk_fma_f32 v[148:149], v[148:149], v[148:149], 1.0 op_sel_hi:[1,1,0]
    v_pk_fma_f32 v[150:151], v[150:151], v[150:151], 1.0 op_sel_hi:[1,1,0]
    v_pk_fma_f32 v[152:153], v[152:153], v[152:153], 1.0 op_sel_hi:[1,1,0]
    v_pk_fma_f32 v[154:155], v[154:155], v[154:155], 1.0 op_sel_hi:[1,1,0]
    v_pk_fma_f32 v[156:157], v[156:157], v[156:157], 1.0 op_sel_hi:[1,1,0]
    v_pk_fma_f32 v[158:159], v[158:159], v[158:159], 1.0 op_sel_hi:[1,1,0]
    v_rcp_f32 v144, v144
    v_rcp_f32 v145, v145
    v_rcp_f32 v146, v146
    v_rcp_f32 v147, v147
    v_rcp_f32 v148, v148
    v_rcp_f32 v149, v149
    v_rcp_f32 v150, v150
    v_rcp_f32 v151, v151
    v_rcp_f32 v152, v152
    v_rcp_f32 v153, v153
    v_rcp_f32 v154, v154
    v_rcp_f32 v155, v155
    v_rcp_f32 v156, v156
    v_rcp_f32 v157, v157
    v_rcp_f32 v158, v158
    v_rcp_f32 v159, v159
    v_pk_fma_f32 v[144:145], v[144:145], s[44:45], v[26:27] op_sel_hi:[1,0,0]
    v_pk_fma_f32 v[146:147], v[146:147], s[44:45], v[26:27] op_sel_hi:[1,0,0]
    v_pk_fma_f32 v[148:149], v[148:149], s[44:45], v[26:27] op_sel_hi:[1,0,0]
    v_pk_fma_f32 v[150:151], v[150:151], s[44:45], v[26:27] op_sel_hi:[1,0,0]
    v_pk_fma_f32 v[152:153], v[152:153], s[44:45], v[26:27] op_sel_hi:[1,0,0]
    v_pk_fma_f32 v[154:155], v[154:155], s[44:45], v[26:27] op_sel_hi:[1,0,0]
    v_pk_fma_f32 v[156:157], v[156:157], s[44:45], v[26:27] op_sel_hi:[1,0,0]
    v_pk_fma_f32 v[158:159], v[158:159], s[44:45], v[26:27] op_sel_hi:[1,0,0]
    v_pk_mul_f32 v[96:97], v[96:97], v[144:145]
    v_pk_mul_f32 v[98:99], v[98:99], v[146:147]
    v_pk_mul_f32 v[100:101], v[100:101], v[148:149]
    v_pk_mul_f32 v[102:103], v[102:103], v[150:151]
    v_pk_mul_f32 v[104:105], v[104:105], v[152:153]
    v_pk_mul_f32 v[106:107], v[106:107], v[154:155]
    v_pk_mul_f32 v[108:109], v[108:109], v[156:157]
    v_pk_mul_f32 v[110:111], v[110:111], v[158:159]
    v_cvt_pk_bf16_f32 v144, v96, v97
    v_cvt_pk_bf16_f32 v145, v98, v99
    v_cvt_pk_bf16_f32 v146, v100, v101
    v_cvt_pk_bf16_f32 v147, v102, v103
    v_cvt_pk_bf16_f32 v148, v104, v105
    v_cvt_pk_bf16_f32 v149, v106, v107
    v_cvt_pk_bf16_f32 v150, v108, v109
    v_cvt_pk_bf16_f32 v151, v110, v111
    buffer_store_dwordx4 v[144:147], v4, s[12:15], s42 offen sc1
    buffer_store_dwordx4 v[148:151], v4, s[12:15], s42 offen offset:1024 sc1
k4_kernel_fin:
    s_lshl_b32 s38, s29, 8
    s_add_u32 s38, s38, 17240064
    s_waitcnt vmcnt(0)
    s_barrier
    s_cmp_lg_u32 s47, 0
    s_cbranch_scc1 k4_kernel_23
    s_mov_b64 exec, 1
    v_mov_b32 v3, 1
    buffer_atomic_add v3, off, s[12:15], s38
    s_mov_b64 exec, -1
k4_kernel_23:
    s_branch k4_kernel_exit
k4_kernel_loader:
    s_waitcnt lgkmcnt(0)
    s_cmp_ge_u32 s47, 8
    s_cbranch_scc1 k4_kernel_xloader
    v_add_u32 v19, 0, v0
    v_mul_u32_u24 v20, 171, v19
    v_lshrrev_b32 v20, 11, v20
    v_mul_u32_u24 v21, 12, v20
    v_sub_u32 v21, v19, v21
    v_lshlrev_b32 v21, 4, v21
    v_mul_u32_u24 v20, 2752, v20
    v_add_u32 v1, v20, v21
    v_add_u32 v19, 64, v0
    v_mul_u32_u24 v20, 171, v19
    v_lshrrev_b32 v20, 11, v20
    v_mul_u32_u24 v21, 12, v20
    v_sub_u32 v21, v19, v21
    v_lshlrev_b32 v21, 4, v21
    v_mul_u32_u24 v20, 2752, v20
    v_add_u32 v2, v20, v21
    v_add_u32 v19, 128, v0
    v_mul_u32_u24 v20, 171, v19
    v_lshrrev_b32 v20, 11, v20
    v_mul_u32_u24 v21, 12, v20
    v_sub_u32 v21, v19, v21
    v_lshlrev_b32 v21, 4, v21
    v_mul_u32_u24 v20, 2752, v20
    v_add_u32 v3, v20, v21
    s_mov_b32 s4, s20
    s_mov_b32 s5, s21
    s_mov_b32 s6, 1409024
    s_mov_b32 s7, 0x00020000
    s_mul_i32 s34, s26, 44032
    s_mul_i32 s36, s30, 192
    s_add_u32 s34, s34, s36
    s_mul_i32 s35, s26, 3072
    s_add_u32 m0, s35, 0
    s_add_u32 s37, s34, 0
    buffer_load_dwordx4 v1, s[4:7], s37 offen lds
    s_add_u32 m0, s35, 1024
    s_add_u32 s37, s34, 0
    buffer_load_dwordx4 v2, s[4:7], s37 offen lds
    s_add_u32 m0, s35, 2048
    s_add_u32 s37, s34, 0
    buffer_load_dwordx4 v3, s[4:7], s37 offen lds
    s_add_u32 m0, s35, 28672
    s_add_u32 s37, s34, 176128
    buffer_load_dwordx4 v1, s[4:7], s37 offen lds
    s_add_u32 m0, s35, 29696
    s_add_u32 s37, s34, 176128
    buffer_load_dwordx4 v2, s[4:7], s37 offen lds
    s_add_u32 m0, s35, 30720
    s_add_u32 s37, s34, 176128
    buffer_load_dwordx4 v3, s[4:7], s37 offen lds
    s_add_u32 m0, s35, 57344
    s_add_u32 s37, s34, 352256
    buffer_load_dwordx4 v1, s[4:7], s37 offen lds
    s_add_u32 m0, s35, 58368
    s_add_u32 s37, s34, 352256
    buffer_load_dwordx4 v2, s[4:7], s37 offen lds
    s_add_u32 m0, s35, 59392
    s_add_u32 s37, s34, 352256
    buffer_load_dwordx4 v3, s[4:7], s37 offen lds
    s_add_u32 m0, s35, 86016
    s_add_u32 s37, s34, 528384
    buffer_load_dwordx4 v1, s[4:7], s37 offen lds
    s_add_u32 m0, s35, 87040
    s_add_u32 s37, s34, 528384
    buffer_load_dwordx4 v2, s[4:7], s37 offen lds
    s_add_u32 m0, s35, 88064
    s_add_u32 s37, s34, 528384
    buffer_load_dwordx4 v3, s[4:7], s37 offen lds
    s_add_u32 m0, s35, 114688
    s_add_u32 s37, s34, 704512
    buffer_load_dwordx4 v1, s[4:7], s37 offen lds
    s_add_u32 m0, s35, 115712
    s_add_u32 s37, s34, 704512
    buffer_load_dwordx4 v2, s[4:7], s37 offen lds
    s_add_u32 m0, s35, 116736
    s_add_u32 s37, s34, 704512
    buffer_load_dwordx4 v3, s[4:7], s37 offen lds
    s_barrier
    v_mov_b32 v12, 0
    v_mov_b32 v13, 0
    v_mov_b32 v14, 0
    v_mov_b32 v15, 0
    v_mov_b32 v16, 0
    v_mov_b32 v17, 0
    v_mov_b32 v18, 0
    s_mov_b32 s33, 0x3f803f80
    v_add_u32 v10, s35, v10
    s_waitcnt vmcnt(12)
    s_barrier
    ds_read_b64_tr_b16 v[80:81], v10 offset:0
    ds_read_b64_tr_b16 v[82:83], v10 offset:1536
    ds_read_b64_tr_b16 v[84:85], v10 offset:64
    ds_read_b64_tr_b16 v[86:87], v10 offset:1600
    ds_read_b64_tr_b16 v[88:89], v10 offset:128
    ds_read_b64_tr_b16 v[90:91], v10 offset:1664
    s_waitcnt lgkmcnt(0)
    v_dot2c_f32_bf16 v16, s33, v80
    v_dot2c_f32_bf16 v17, s33, v84
    v_dot2c_f32_bf16 v18, s33, v88
    v_dot2c_f32_bf16 v16, s33, v81
    v_dot2c_f32_bf16 v17, s33, v85
    v_dot2c_f32_bf16 v18, s33, v89
    v_dot2c_f32_bf16 v16, s33, v82
    v_dot2c_f32_bf16 v17, s33, v86
    v_dot2c_f32_bf16 v18, s33, v90
    v_dot2c_f32_bf16 v16, s33, v83
    v_dot2c_f32_bf16 v17, s33, v87
    v_dot2c_f32_bf16 v18, s33, v91
    s_waitcnt vmcnt(9)
    s_barrier
    s_add_u32 m0, s35, 0
    s_add_u32 s37, s34, 880640
    buffer_load_dwordx4 v1, s[4:7], s37 offen lds
    s_add_u32 m0, s35, 1024
    s_add_u32 s37, s34, 880640
    buffer_load_dwordx4 v2, s[4:7], s37 offen lds
    s_add_u32 m0, s35, 2048
    s_add_u32 s37, s34, 880640
    buffer_load_dwordx4 v3, s[4:7], s37 offen lds
    v_add_u32 v6, 0x7000, v6
    v_add_u32 v7, 0x7000, v7
    v_add_u32 v8, 0x7000, v8
    v_add_u32 v9, 0x7000, v9
    v_add_u32 v10, 0x7000, v10
    ds_read_b64_tr_b16 v[80:81], v10 offset:0
    ds_read_b64_tr_b16 v[82:83], v10 offset:1536
    ds_read_b64_tr_b16 v[84:85], v10 offset:64
    ds_read_b64_tr_b16 v[86:87], v10 offset:1600
    ds_read_b64_tr_b16 v[88:89], v10 offset:128
    ds_read_b64_tr_b16 v[90:91], v10 offset:1664
    s_waitcnt lgkmcnt(0)
    v_dot2c_f32_bf16 v16, s33, v80
    v_dot2c_f32_bf16 v17, s33, v84
    v_dot2c_f32_bf16 v18, s33, v88
    v_dot2c_f32_bf16 v16, s33, v81
    v_dot2c_f32_bf16 v17, s33, v85
    v_dot2c_f32_bf16 v18, s33, v89
    v_dot2c_f32_bf16 v16, s33, v82
    v_dot2c_f32_bf16 v17, s33, v86
    v_dot2c_f32_bf16 v18, s33, v90
    v_dot2c_f32_bf16 v16, s33, v83
    v_dot2c_f32_bf16 v17, s33, v87
    v_dot2c_f32_bf16 v18, s33, v91
    s_waitcnt vmcnt(9)
    s_barrier
    s_add_u32 m0, s35, 28672
    s_add_u32 s37, s34, 1056768
    buffer_load_dwordx4 v1, s[4:7], s37 offen lds
    s_add_u32 m0, s35, 29696
    s_add_u32 s37, s34, 1056768
    buffer_load_dwordx4 v2, s[4:7], s37 offen lds
    s_add_u32 m0, s35, 30720
    s_add_u32 s37, s34, 1056768
    buffer_load_dwordx4 v3, s[4:7], s37 offen lds
    v_add_u32 v6, 0x7000, v6
    v_add_u32 v7, 0x7000, v7
    v_add_u32 v8, 0x7000, v8
    v_add_u32 v9, 0x7000, v9
    v_add_u32 v10, 0x7000, v10
    ds_read_b64_tr_b16 v[80:81], v10 offset:0
    ds_read_b64_tr_b16 v[82:83], v10 offset:1536
    ds_read_b64_tr_b16 v[84:85], v10 offset:64
    ds_read_b64_tr_b16 v[86:87], v10 offset:1600
    ds_read_b64_tr_b16 v[88:89], v10 offset:128
    ds_read_b64_tr_b16 v[90:91], v10 offset:1664
    s_waitcnt lgkmcnt(0)
    v_dot2c_f32_bf16 v16, s33, v80
    v_dot2c_f32_bf16 v17, s33, v84
    v_dot2c_f32_bf16 v18, s33, v88
    v_dot2c_f32_bf16 v16, s33, v81
    v_dot2c_f32_bf16 v17, s33, v85
    v_dot2c_f32_bf16 v18, s33, v89
    v_dot2c_f32_bf16 v16, s33, v82
    v_dot2c_f32_bf16 v17, s33, v86
    v_dot2c_f32_bf16 v18, s33, v90
    v_dot2c_f32_bf16 v16, s33, v83
    v_dot2c_f32_bf16 v17, s33, v87
    v_dot2c_f32_bf16 v18, s33, v91
    s_waitcnt vmcnt(9)
    s_barrier
    s_add_u32 m0, s35, 57344
    s_add_u32 s37, s34, 1232896
    buffer_load_dwordx4 v1, s[4:7], s37 offen lds
    s_add_u32 m0, s35, 58368
    s_add_u32 s37, s34, 1232896
    buffer_load_dwordx4 v2, s[4:7], s37 offen lds
    s_add_u32 m0, s35, 59392
    s_add_u32 s37, s34, 1232896
    buffer_load_dwordx4 v3, s[4:7], s37 offen lds
    v_add_u32 v6, 0x7000, v6
    v_add_u32 v7, 0x7000, v7
    v_add_u32 v8, 0x7000, v8
    v_add_u32 v9, 0x7000, v9
    v_add_u32 v10, 0x7000, v10
    ds_read_b64_tr_b16 v[80:81], v10 offset:0
    ds_read_b64_tr_b16 v[82:83], v10 offset:1536
    ds_read_b64_tr_b16 v[84:85], v10 offset:64
    ds_read_b64_tr_b16 v[86:87], v10 offset:1600
    ds_read_b64_tr_b16 v[88:89], v10 offset:128
    ds_read_b64_tr_b16 v[90:91], v10 offset:1664
    s_waitcnt lgkmcnt(0)
    v_dot2c_f32_bf16 v16, s33, v80
    v_dot2c_f32_bf16 v17, s33, v84
    v_dot2c_f32_bf16 v18, s33, v88
    v_dot2c_f32_bf16 v16, s33, v81
    v_dot2c_f32_bf16 v17, s33, v85
    v_dot2c_f32_bf16 v18, s33, v89
    v_dot2c_f32_bf16 v16, s33, v82
    v_dot2c_f32_bf16 v17, s33, v86
    v_dot2c_f32_bf16 v18, s33, v90
    v_dot2c_f32_bf16 v16, s33, v83
    v_dot2c_f32_bf16 v17, s33, v87
    v_dot2c_f32_bf16 v18, s33, v91
    s_waitcnt vmcnt(9)
    s_barrier
    v_add_u32 v6, 0x7000, v6
    v_add_u32 v7, 0x7000, v7
    v_add_u32 v8, 0x7000, v8
    v_add_u32 v9, 0x7000, v9
    v_add_u32 v10, 0x7000, v10
    ds_read_b64_tr_b16 v[80:81], v10 offset:0
    ds_read_b64_tr_b16 v[82:83], v10 offset:1536
    ds_read_b64_tr_b16 v[84:85], v10 offset:64
    ds_read_b64_tr_b16 v[86:87], v10 offset:1600
    ds_read_b64_tr_b16 v[88:89], v10 offset:128
    ds_read_b64_tr_b16 v[90:91], v10 offset:1664
    s_waitcnt lgkmcnt(0)
    v_dot2c_f32_bf16 v16, s33, v80
    v_dot2c_f32_bf16 v17, s33, v84
    v_dot2c_f32_bf16 v18, s33, v88
    v_dot2c_f32_bf16 v16, s33, v81
    v_dot2c_f32_bf16 v17, s33, v85
    v_dot2c_f32_bf16 v18, s33, v89
    v_dot2c_f32_bf16 v16, s33, v82
    v_dot2c_f32_bf16 v17, s33, v86
    v_dot2c_f32_bf16 v18, s33, v90
    v_dot2c_f32_bf16 v16, s33, v83
    v_dot2c_f32_bf16 v17, s33, v87
    v_dot2c_f32_bf16 v18, s33, v91
    s_waitcnt vmcnt(6)
    s_barrier
    v_add_u32 v6, 0xfffe4000, v6
    v_add_u32 v7, 0xfffe4000, v7
    v_add_u32 v8, 0xfffe4000, v8
    v_add_u32 v9, 0xfffe4000, v9
    v_add_u32 v10, 0xfffe4000, v10
    ds_read_b64_tr_b16 v[80:81], v10 offset:0
    ds_read_b64_tr_b16 v[82:83], v10 offset:1536
    ds_read_b64_tr_b16 v[84:85], v10 offset:64
    ds_read_b64_tr_b16 v[86:87], v10 offset:1600
    ds_read_b64_tr_b16 v[88:89], v10 offset:128
    ds_read_b64_tr_b16 v[90:91], v10 offset:1664
    s_waitcnt lgkmcnt(0)
    v_dot2c_f32_bf16 v16, s33, v80
    v_dot2c_f32_bf16 v17, s33, v84
    v_dot2c_f32_bf16 v18, s33, v88
    v_dot2c_f32_bf16 v16, s33, v81
    v_dot2c_f32_bf16 v17, s33, v85
    v_dot2c_f32_bf16 v18, s33, v89
    v_dot2c_f32_bf16 v16, s33, v82
    v_dot2c_f32_bf16 v17, s33, v86
    v_dot2c_f32_bf16 v18, s33, v90
    v_dot2c_f32_bf16 v16, s33, v83
    v_dot2c_f32_bf16 v17, s33, v87
    v_dot2c_f32_bf16 v18, s33, v91
    s_waitcnt vmcnt(3)
    s_barrier
    v_add_u32 v6, 0x7000, v6
    v_add_u32 v7, 0x7000, v7
    v_add_u32 v8, 0x7000, v8
    v_add_u32 v9, 0x7000, v9
    v_add_u32 v10, 0x7000, v10
    ds_read_b64_tr_b16 v[80:81], v10 offset:0
    ds_read_b64_tr_b16 v[82:83], v10 offset:1536
    ds_read_b64_tr_b16 v[84:85], v10 offset:64
    ds_read_b64_tr_b16 v[86:87], v10 offset:1600
    ds_read_b64_tr_b16 v[88:89], v10 offset:128
    ds_read_b64_tr_b16 v[90:91], v10 offset:1664
    s_waitcnt lgkmcnt(0)
    v_dot2c_f32_bf16 v16, s33, v80
    v_dot2c_f32_bf16 v17, s33, v84
    v_dot2c_f32_bf16 v18, s33, v88
    v_dot2c_f32_bf16 v16, s33, v81
    v_dot2c_f32_bf16 v17, s33, v85
    v_dot2c_f32_bf16 v18, s33, v89
    v_dot2c_f32_bf16 v16, s33, v82
    v_dot2c_f32_bf16 v17, s33, v86
    v_dot2c_f32_bf16 v18, s33, v90
    v_dot2c_f32_bf16 v16, s33, v83
    v_dot2c_f32_bf16 v17, s33, v87
    v_dot2c_f32_bf16 v18, s33, v91
    s_waitcnt vmcnt(0)
    s_barrier
    v_add_u32 v6, 0x7000, v6
    v_add_u32 v7, 0x7000, v7
    v_add_u32 v8, 0x7000, v8
    v_add_u32 v9, 0x7000, v9
    v_add_u32 v10, 0x7000, v10
    ds_read_b64_tr_b16 v[80:81], v10 offset:0
    ds_read_b64_tr_b16 v[82:83], v10 offset:1536
    ds_read_b64_tr_b16 v[84:85], v10 offset:64
    ds_read_b64_tr_b16 v[86:87], v10 offset:1600
    ds_read_b64_tr_b16 v[88:89], v10 offset:128
    ds_read_b64_tr_b16 v[90:91], v10 offset:1664
    s_waitcnt lgkmcnt(0)
    v_dot2c_f32_bf16 v16, s33, v80
    v_dot2c_f32_bf16 v17, s33, v84
    v_dot2c_f32_bf16 v18, s33, v88
    v_dot2c_f32_bf16 v16, s33, v81
    v_dot2c_f32_bf16 v17, s33, v85
    v_dot2c_f32_bf16 v18, s33, v89
    v_dot2c_f32_bf16 v16, s33, v82
    v_dot2c_f32_bf16 v17, s33, v86
    v_dot2c_f32_bf16 v18, s33, v90
    v_dot2c_f32_bf16 v16, s33, v83
    v_dot2c_f32_bf16 v17, s33, v87
    v_dot2c_f32_bf16 v18, s33, v91
    s_lshl_b32 s37, s26, 1
    s_mul_i32 s37, s37, 384
    s_add_u32 s37, s37, 143360
    v_mul_u32_u24 v19, 384, v30
    v_lshl_add_u32 v19, v31, 2, v19
    v_add_u32 v19, s37, v19
    ds_write_b32 v19, v16 offset:0
    ds_write_b32 v19, v17 offset:128
    ds_write_b32 v19, v18 offset:256
    s_waitcnt lgkmcnt(0)
    s_barrier
    s_endpgm
k4_kernel_xloader:
    v_mov_b32 v5, v4
    s_mov_b32 s8, s24
    s_mov_b32 s9, s25
    s_mov_b32 s10, 33554432
    s_mov_b32 s11, 0x00020000
    s_lshl_b32 s36, s31, 15
    s_add_u32 s36, s36, 8388608
    s_cmp_lg_u32 s47, 8
    s_cbranch_scc1 k4_kernel_24
    s_lshl_b32 s38, s29, 8
    s_add_u32 s38, s38, 17235968
    s_mov_b64 exec, 1
    s_mov_b32 s39, 0
    buffer_load_dword v32, off, s[8:11], s38 sc1
k4_kernel_25:
    s_waitcnt vmcnt(0)
    v_readfirstlane_b32 s37, v32
    s_cmp_ge_u32 s37, 16
    s_cbranch_scc1 k4_kernel_26
    buffer_load_dword v32, off, s[8:11], s38 sc1
    s_add_u32 s39, s39, 1
    s_cmp_lt_u32 s39, 0x8000
    s_cbranch_scc1 k4_kernel_25
k4_kernel_26:
    s_mov_b64 exec, -1
k4_kernel_24:
    s_barrier
    s_add_u32 m0, s32, 0
    s_add_u32 s37, s36, 0
    buffer_load_dwordx4 v4, s[8:11], s37 offen lds
    s_add_u32 m0, s32, 1024
    s_add_u32 s37, s36, 1024
    buffer_load_dwordx4 v5, s[8:11], s37 offen lds
    s_add_u32 m0, s32, 2048
    s_add_u32 s37, s36, 2048
    buffer_load_dwordx4 v4, s[8:11], s37 offen lds
    s_add_u32 m0, s32, 3072
    s_add_u32 s37, s36, 3072
    buffer_load_dwordx4 v5, s[8:11], s37 offen lds
    s_add_u32 m0, s32, 28672
    s_add_u32 s37, s36, 4096
    buffer_load_dwordx4 v4, s[8:11], s37 offen lds
    s_add_u32 m0, s32, 29696
    s_add_u32 s37, s36, 5120
    buffer_load_dwordx4 v5, s[8:11], s37 offen lds
    s_add_u32 m0, s32, 30720
    s_add_u32 s37, s36, 6144
    buffer_load_dwordx4 v4, s[8:11], s37 offen lds
    s_add_u32 m0, s32, 31744
    s_add_u32 s37, s36, 7168
    buffer_load_dwordx4 v5, s[8:11], s37 offen lds
    v_mov_b32 v12, 0
    v_mov_b32 v13, 0
    s_waitcnt vmcnt(4)
    s_barrier
    s_add_u32 m0, s32, 57344
    s_add_u32 s37, s36, 8192
    buffer_load_dwordx4 v4, s[8:11], s37 offen lds
    s_add_u32 m0, s32, 58368
    s_add_u32 s37, s36, 9216
    buffer_load_dwordx4 v5, s[8:11], s37 offen lds
    s_add_u32 m0, s32, 59392
    s_add_u32 s37, s36, 10240
    buffer_load_dwordx4 v4, s[8:11], s37 offen lds
    s_add_u32 m0, s32, 60416
    s_add_u32 s37, s36, 11264
    buffer_load_dwordx4 v5, s[8:11], s37 offen lds
    s_add_u32 m0, s32, 86016
    s_add_u32 s37, s36, 12288
    buffer_load_dwordx4 v4, s[8:11], s37 offen lds
    s_add_u32 m0, s32, 87040
    s_add_u32 s37, s36, 13312
    buffer_load_dwordx4 v5, s[8:11], s37 offen lds
    s_add_u32 m0, s32, 88064
    s_add_u32 s37, s36, 14336
    buffer_load_dwordx4 v4, s[8:11], s37 offen lds
    s_add_u32 m0, s32, 89088
    s_add_u32 s37, s36, 15360
    buffer_load_dwordx4 v5, s[8:11], s37 offen lds
    s_waitcnt vmcnt(8)
    s_barrier
    s_add_u32 m0, s32, 114688
    s_add_u32 s37, s36, 16384
    buffer_load_dwordx4 v4, s[8:11], s37 offen lds
    s_add_u32 m0, s32, 115712
    s_add_u32 s37, s36, 17408
    buffer_load_dwordx4 v5, s[8:11], s37 offen lds
    s_add_u32 m0, s32, 116736
    s_add_u32 s37, s36, 18432
    buffer_load_dwordx4 v4, s[8:11], s37 offen lds
    s_add_u32 m0, s32, 117760
    s_add_u32 s37, s36, 19456
    buffer_load_dwordx4 v5, s[8:11], s37 offen lds
    s_add_u32 m0, s32, 0
    s_add_u32 s37, s36, 20480
    buffer_load_dwordx4 v4, s[8:11], s37 offen lds
    s_add_u32 m0, s32, 1024
    s_add_u32 s37, s36, 21504
    buffer_load_dwordx4 v5, s[8:11], s37 offen lds
    s_add_u32 m0, s32, 2048
    s_add_u32 s37, s36, 22528
    buffer_load_dwordx4 v4, s[8:11], s37 offen lds
    s_add_u32 m0, s32, 3072
    s_add_u32 s37, s36, 23552
    buffer_load_dwordx4 v5, s[8:11], s37 offen lds
    v_add_u32 v6, 0x7000, v6
    v_add_u32 v7, 0x7000, v7
    v_add_u32 v8, 0x7000, v8
    v_add_u32 v9, 0x7000, v9
    v_add_u32 v10, 0x7000, v10
    s_waitcnt vmcnt(12)
    s_barrier
    s_add_u32 m0, s32, 28672
    s_add_u32 s37, s36, 24576
    buffer_load_dwordx4 v4, s[8:11], s37 offen lds
    s_add_u32 m0, s32, 29696
    s_add_u32 s37, s36, 25600
    buffer_load_dwordx4 v5, s[8:11], s37 offen lds
    s_add_u32 m0, s32, 30720
    s_add_u32 s37, s36, 26624
    buffer_load_dwordx4 v4, s[8:11], s37 offen lds
    s_add_u32 m0, s32, 31744
    s_add_u32 s37, s36, 27648
    buffer_load_dwordx4 v5, s[8:11], s37 offen lds
    v_add_u32 v6, 0x7000, v6
    v_add_u32 v7, 0x7000, v7
    v_add_u32 v8, 0x7000, v8
    v_add_u32 v9, 0x7000, v9
    v_add_u32 v10, 0x7000, v10
    s_waitcnt vmcnt(12)
    s_barrier
    s_add_u32 m0, s32, 57344
    s_add_u32 s37, s36, 28672
    buffer_load_dwordx4 v4, s[8:11], s37 offen lds
    s_add_u32 m0, s32, 58368
    s_add_u32 s37, s36, 29696
    buffer_load_dwordx4 v5, s[8:11], s37 offen lds
    s_add_u32 m0, s32, 59392
    s_add_u32 s37, s36, 30720
    buffer_load_dwordx4 v4, s[8:11], s37 offen lds
    s_add_u32 m0, s32, 60416
    s_add_u32 s37, s36, 31744
    buffer_load_dwordx4 v5, s[8:11], s37 offen lds
    v_add_u32 v6, 0x7000, v6
    v_add_u32 v7, 0x7000, v7
    v_add_u32 v8, 0x7000, v8
    v_add_u32 v9, 0x7000, v9
    v_add_u32 v10, 0x7000, v10
    s_waitcnt vmcnt(12)
    s_barrier
    v_add_u32 v6, 0x7000, v6
    v_add_u32 v7, 0x7000, v7
    v_add_u32 v8, 0x7000, v8
    v_add_u32 v9, 0x7000, v9
    v_add_u32 v10, 0x7000, v10
    s_waitcnt vmcnt(8)
    s_barrier
    v_add_u32 v6, 0xfffe4000, v6
    v_add_u32 v7, 0xfffe4000, v7
    v_add_u32 v8, 0xfffe4000, v8
    v_add_u32 v9, 0xfffe4000, v9
    v_add_u32 v10, 0xfffe4000, v10
    s_waitcnt vmcnt(4)
    s_barrier
    v_add_u32 v6, 0x7000, v6
    v_add_u32 v7, 0x7000, v7
    v_add_u32 v8, 0x7000, v8
    v_add_u32 v9, 0x7000, v9
    v_add_u32 v10, 0x7000, v10
    s_waitcnt vmcnt(0)
    s_barrier
    v_add_u32 v6, 0x7000, v6
    v_add_u32 v7, 0x7000, v7
    v_add_u32 v8, 0x7000, v8
    v_add_u32 v9, 0x7000, v9
    v_add_u32 v10, 0x7000, v10
    s_waitcnt lgkmcnt(0)
    s_barrier
    s_endpgm
k4_kernel_exit:
    s_endpgm
k5_kernel:
    s_cmp_ge_u32 s2, 256
    s_cbranch_scc1 k5_kernel_exit
    s_load_dwordx4 s[20:23], s[0:1], 48
    s_load_dwordx2 s[24:25], s[0:1], 72
    v_lshrrev_b32 v1, 6, v0
    v_and_b32 v0, 63, v0
    s_nop 0
    v_readfirstlane_b32 s47, v1
    s_and_b32 s26, s47, 3
    s_and_b32 s27, s2, 7
    s_lshr_b32 s28, s2, 3
    s_lshl_b32 s29, s27, 2
    s_and_b32 s30, s28, 3
    s_add_u32 s29, s29, s30
    s_lshr_b32 s30, s28, 2
    s_and_b32 s27, s26, 1
    s_lshr_b32 s28, s26, 1
    s_lshl_b32 s31, s29, 1
    s_add_u32 s31, s31, s27
    v_lshrrev_b32 v30, 5, v0
    v_and_b32 v31, 31, v0
    v_lshlrev_b32 v4, 4, v0
    s_cmp_ge_u32 s47, 4
    s_cbranch_scc1 k5_kernel_loader
    s_lshl_b32 s32, s28, 11
    v_mul_u32_u24 v19, 4, v30
    v_bfe_u32 v20, v0, 2, 2
    v_add_u32 v19, v19, v20
    v_lshlrev_b32 v19, 7, v19
    v_bfe_u32 v21, v0, 4, 1
    v_lshlrev_b32 v21, 1, v21
    v_bfe_u32 v22, v0, 1, 1
    v_add_u32 v21, v21, v22
    v_bfe_u32 v22, v0, 3, 1
    v_lshlrev_b32 v22, 2, v22
    v_xor_b32 v21, v21, v22
    v_lshl_add_u32 v19, v21, 4, v19
    v_and_b32 v21, 1, v0
    v_lshl_add_u32 v19, v21, 3, v19
    v_add_u32 v6, s32, v19
    v_xor_b32 v7, 64, v6
    s_lshl_b32 s33, s26, 10
    s_add_u32 s33, s33, 4096
    v_add_u32 v8, s33, v4
    v_add_u32 v9, 65536, v6
    v_add_u32 v10, 65536, v7
    v_add_u32 v11, 65536, v8
    v_mov_b32 v32, 0
    v_mov_b32 v33, 0
    v_mov_b32 v34, 0
    v_mov_b32 v35, 0
    v_mov_b32 v36, 0
    v_mov_b32 v37, 0
    v_mov_b32 v38, 0
    v_mov_b32 v39, 0
    v_mov_b32 v40, 0
    v_mov_b32 v41, 0
    v_mov_b32 v42, 0
    v_mov_b32 v43, 0
    v_mov_b32 v44, 0
    v_mov_b32 v45, 0
    v_mov_b32 v46, 0
    v_mov_b32 v47, 0
    v_mov_b32 v48, 0
    v_mov_b32 v49, 0
    v_mov_b32 v50, 0
    v_mov_b32 v51, 0
    v_mov_b32 v52, 0
    v_mov_b32 v53, 0
    v_mov_b32 v54, 0
    v_mov_b32 v55, 0
    v_mov_b32 v56, 0
    v_mov_b32 v57, 0
    v_mov_b32 v58, 0
    v_mov_b32 v59, 0
    v_mov_b32 v60, 0
    v_mov_b32 v61, 0
    v_mov_b32 v62, 0
    v_mov_b32 v63, 0
    s_waitcnt lgkmcnt(0)
    s_mov_b32 s8, s24
    s_mov_b32 s9, s25
    s_mov_b32 s10, 33554432
    s_mov_b32 s11, 0x00020000
    s_mov_b32 s12, s22
    s_mov_b32 s13, s23
    s_mov_b32 s14, 2097152
    s_mov_b32 s15, 0x00020000
    s_barrier
    s_lshl_b32 s38, s31, 15
    s_lshl_b32 s33, s30, 12
    s_add_u32 s38, s38, s33
    s_lshl_b32 s33, s28, 11
    s_add_u32 s38, s38, s33
    s_add_u32 s38, s38, 8388608
    buffer_load_dwordx4 v[64:67], v4, s[8:11], s38 offen
    buffer_load_dwordx4 v[68:71], v4, s[8:11], s38 offen offset:1024
    s_barrier
    ds_read_b128 v[88:91], v8 offset:0
    ds_read_b64_tr_b16 v[72:73], v6 offset:0
    ds_read_b64_tr_b16 v[74:75], v6 offset:1024
    ds_read_b64_tr_b16 v[76:77], v7 offset:0
    ds_read_b64_tr_b16 v[78:79], v7 offset:1024
    s_mov_b32 s48, 0
k5_kernel_27:
    ds_read_b128 v[92:95], v8 offset:8192
    ds_read_b64_tr_b16 v[80:81], v6 offset:8192
    ds_read_b64_tr_b16 v[82:83], v6 offset:9216
    ds_read_b64_tr_b16 v[84:85], v7 offset:8192
    ds_read_b64_tr_b16 v[86:87], v7 offset:9216
    s_waitcnt lgkmcnt(5)
    v_mfma_f32_32x32x16_bf16 v[32:47], v[72:75], v[88:91], v[32:47]
    v_mfma_f32_32x32x16_bf16 v[48:63], v[76:79], v[88:91], v[48:63]
    ds_read_b128 v[88:91], v8 offset:16384
    ds_read_b64_tr_b16 v[72:73], v6 offset:16384
    ds_read_b64_tr_b16 v[74:75], v6 offset:17408
    ds_read_b64_tr_b16 v[76:77], v7 offset:16384
    ds_read_b64_tr_b16 v[78:79], v7 offset:17408
    s_waitcnt lgkmcnt(5)
    v_mfma_f32_32x32x16_bf16 v[32:47], v[80:83], v[92:95], v[32:47]
    v_mfma_f32_32x32x16_bf16 v[48:63], v[84:87], v[92:95], v[48:63]
    ds_read_b128 v[92:95], v8 offset:24576
    ds_read_b64_tr_b16 v[80:81], v6 offset:24576
    ds_read_b64_tr_b16 v[82:83], v6 offset:25600
    ds_read_b64_tr_b16 v[84:85], v7 offset:24576
    ds_read_b64_tr_b16 v[86:87], v7 offset:25600
    s_waitcnt lgkmcnt(5)
    v_mfma_f32_32x32x16_bf16 v[32:47], v[72:75], v[88:91], v[32:47]
    v_mfma_f32_32x32x16_bf16 v[48:63], v[76:79], v[88:91], v[48:63]
    s_waitcnt lgkmcnt(0)
    s_barrier
    ds_read_b128 v[88:91], v8 offset:32768
    ds_read_b64_tr_b16 v[72:73], v6 offset:32768
    ds_read_b64_tr_b16 v[74:75], v6 offset:33792
    ds_read_b64_tr_b16 v[76:77], v7 offset:32768
    ds_read_b64_tr_b16 v[78:79], v7 offset:33792
    v_mfma_f32_32x32x16_bf16 v[32:47], v[80:83], v[92:95], v[32:47]
    v_mfma_f32_32x32x16_bf16 v[48:63], v[84:87], v[92:95], v[48:63]
    ds_read_b128 v[92:95], v8 offset:40960
    ds_read_b64_tr_b16 v[80:81], v6 offset:40960
    ds_read_b64_tr_b16 v[82:83], v6 offset:41984
    ds_read_b64_tr_b16 v[84:85], v7 offset:40960
    ds_read_b64_tr_b16 v[86:87], v7 offset:41984
    s_waitcnt lgkmcnt(5)
    v_mfma_f32_32x32x16_bf16 v[32:47], v[72:75], v[88:91], v[32:47]
    v_mfma_f32_32x32x16_bf16 v[48:63], v[76:79], v[88:91], v[48:63]
    ds_read_b128 v[88:91], v8 offset:49152
    ds_read_b64_tr_b16 v[72:73], v6 offset:49152
    ds_read_b64_tr_b16 v[74:75], v6 offset:50176
    ds_read_b64_tr_b16 v[76:77], v7 offset:49152
    ds_read_b64_tr_b16 v[78:79], v7 offset:50176
    s_waitcnt lgkmcnt(5)
    v_mfma_f32_32x32x16_bf16 v[32:47], v[80:83], v[92:95], v[32:47]
    v_mfma_f32_32x32x16_bf16 v[48:63], v[84:87], v[92:95], v[48:63]
    ds_read_b128 v[92:95], v8 offset:57344
    ds_read_b64_tr_b16 v[80:81], v6 offset:57344
    ds_read_b64_tr_b16 v[82:83], v6 offset:58368
    ds_read_b64_tr_b16 v[84:85], v7 offset:57344
    ds_read_b64_tr_b16 v[86:87], v7 offset:58368
    s_waitcnt lgkmcnt(5)
    v_mfma_f32_32x32x16_bf16 v[32:47], v[72:75], v[88:91], v[32:47]
    v_mfma_f32_32x32x16_bf16 v[48:63], v[76:79], v[88:91], v[48:63]
    s_add_u32 s48, s48, 1
    s_cmp_eq_u32 s48, 5
    s_waitcnt lgkmcnt(0)
    s_barrier
    v_swap_b32 v6, v9
    v_swap_b32 v7, v10
    v_swap_b32 v8, v11
    ds_read_b128 v[88:91], v8 offset:0
    ds_read_b64_tr_b16 v[72:73], v6 offset:0
    ds_read_b64_tr_b16 v[74:75], v6 offset:1024
    ds_read_b64_tr_b16 v[76:77], v7 offset:0
    ds_read_b64_tr_b16 v[78:79], v7 offset:1024
    v_mfma_f32_32x32x16_bf16 v[32:47], v[80:83], v[92:95], v[32:47]
    v_mfma_f32_32x32x16_bf16 v[48:63], v[84:87], v[92:95], v[48:63]
    s_cbranch_scc0 k5_kernel_27
    ds_read_b128 v[92:95], v8 offset:8192
    ds_read_b64_tr_b16 v[80:81], v6 offset:8192
    ds_read_b64_tr_b16 v[82:83], v6 offset:9216
    ds_read_b64_tr_b16 v[84:85], v7 offset:8192
    ds_read_b64_tr_b16 v[86:87], v7 offset:9216
    s_waitcnt lgkmcnt(5)
    v_mfma_f32_32x32x16_bf16 v[32:47], v[72:75], v[88:91], v[32:47]
    v_mfma_f32_32x32x16_bf16 v[48:63], v[76:79], v[88:91], v[48:63]
    ds_read_b128 v[88:91], v8 offset:16384
    ds_read_b64_tr_b16 v[72:73], v6 offset:16384
    ds_read_b64_tr_b16 v[74:75], v6 offset:17408
    ds_read_b64_tr_b16 v[76:77], v7 offset:16384
    ds_read_b64_tr_b16 v[78:79], v7 offset:17408
    s_waitcnt lgkmcnt(5)
    v_mfma_f32_32x32x16_bf16 v[32:47], v[80:83], v[92:95], v[32:47]
    v_mfma_f32_32x32x16_bf16 v[48:63], v[84:87], v[92:95], v[48:63]
    s_waitcnt lgkmcnt(0)
    v_mfma_f32_32x32x16_bf16 v[32:47], v[72:75], v[88:91], v[32:47]
    v_mfma_f32_32x32x16_bf16 v[48:63], v[76:79], v[88:91], v[48:63]
    s_lshl_b32 s33, s26, 12
    s_add_u32 s33, s33, 131072
    s_xor_b32 s39, s26, 2
    s_lshl_b32 s39, s39, 12
    s_add_u32 s39, s39, 131072
    v_add_u32 v19, s33, v4
    v_add_u32 v20, s39, v4
    s_cmp_eq_u32 s28, 0
    s_nop 7
    s_nop 3
    s_cbranch_scc1 k5_kernel_29
    ds_write_b128 v19, v[32:35] offset:0
    ds_write_b128 v19, v[36:39] offset:1024
    ds_write_b128 v19, v[40:43] offset:2048
    ds_write_b128 v19, v[44:47] offset:3072
    s_nop 1
    v_mov_b32 v32, v48
    v_mov_b32 v33, v49
    v_mov_b32 v34, v50
    v_mov_b32 v35, v51
    v_mov_b32 v36, v52
    v_mov_b32 v37, v53
    v_mov_b32 v38, v54
    v_mov_b32 v39, v55
    v_mov_b32 v40, v56
    v_mov_b32 v41, v57
    v_mov_b32 v42, v58
    v_mov_b32 v43, v59
    v_mov_b32 v44, v60
    v_mov_b32 v45, v61
    v_mov_b32 v46, v62
    v_mov_b32 v47, v63
    s_branch k5_kernel_30
k5_kernel_29:
    ds_write_b128 v19, v[48:51] offset:0
    ds_write_b128 v19, v[52:55] offset:1024
    ds_write_b128 v19, v[56:59] offset:2048
    ds_write_b128 v19, v[60:63] offset:3072
k5_kernel_30:
    s_waitcnt lgkmcnt(0)
    s_barrier
    ds_read_b128 v[48:51], v20 offset:0
    ds_read_b128 v[52:55], v20 offset:1024
    ds_read_b128 v[56:59], v20 offset:2048
    ds_read_b128 v[60:63], v20 offset:3072
    s_waitcnt vmcnt(0)
    v_lshlrev_b32 v72, 16, v64
    v_and_b32 v73, 0xffff0000, v64
    v_lshlrev_b32 v74, 16, v65
    v_and_b32 v75, 0xffff0000, v65
    v_lshlrev_b32 v76, 16, v66
    v_and_b32 v77, 0xffff0000, v66
    v_lshlrev_b32 v78, 16, v67
    v_and_b32 v79, 0xffff0000, v67
    v_lshlrev_b32 v80, 16, v68
    v_and_b32 v81, 0xffff0000, v68
    v_lshlrev_b32 v82, 16, v69
    v_and_b32 v83, 0xffff0000, v69
    v_lshlrev_b32 v84, 16, v70
    v_and_b32 v85, 0xffff0000, v70
    v_lshlrev_b32 v86, 16, v71
    v_and_b32 v87, 0xffff0000, v71
    v_pk_add_f32 v[32:33], v[32:33], v[72:73]
    v_pk_add_f32 v[34:35], v[34:35], v[74:75]
    v_pk_add_f32 v[36:37], v[36:37], v[76:77]
    v_pk_add_f32 v[38:39], v[38:39], v[78:79]
    v_pk_add_f32 v[40:41], v[40:41], v[80:81]
    v_pk_add_f32 v[42:43], v[42:43], v[82:83]
    v_pk_add_f32 v[44:45], v[44:45], v[84:85]
    v_pk_add_f32 v[46:47], v[46:47], v[86:87]
    s_waitcnt lgkmcnt(0)
    v_pk_add_f32 v[32:33], v[32:33], v[48:49]
    v_pk_add_f32 v[34:35], v[34:35], v[50:51]
    v_pk_add_f32 v[36:37], v[36:37], v[52:53]
    v_pk_add_f32 v[38:39], v[38:39], v[54:55]
    v_pk_add_f32 v[40:41], v[40:41], v[56:57]
    v_pk_add_f32 v[42:43], v[42:43], v[58:59]
    v_pk_add_f32 v[44:45], v[44:45], v[60:61]
    v_pk_add_f32 v[46:47], v[46:47], v[62:63]
    v_cvt_pk_bf16_f32 v64, v32, v33
    v_cvt_pk_bf16_f32 v65, v34, v35
    v_cvt_pk_bf16_f32 v66, v36, v37
    v_cvt_pk_bf16_f32 v67, v38, v39
    v_cvt_pk_bf16_f32 v68, v40, v41
    v_cvt_pk_bf16_f32 v69, v42, v43
    v_cvt_pk_bf16_f32 v70, v44, v45
    v_cvt_pk_bf16_f32 v71, v46, v47
    s_lshl_b32 s38, s31, 15
    s_lshl_b32 s33, s30, 7
    s_add_u32 s38, s38, s33
    s_lshl_b32 s33, s28, 6
    s_add_u32 s38, s38, s33
    v_lshlrev_b32 v19, 10, v31
    v_lshl_add_u32 v19, v30, 4, v19
    v_permlane32_swap_b32 v64, v66
    v_permlane32_swap_b32 v65, v67
    v_permlane32_swap_b32 v68, v70
    v_permlane32_swap_b32 v69, v71
    s_nop 1
    buffer_store_dwordx4 v[64:67], v19, s[12:15], s38 offen
    buffer_store_dwordx4 v[68:71], v19, s[12:15], s38 offen offset:32
    s_branch k5_kernel_exit
k5_kernel_loader:
    v_lshrrev_b32 v19, 3, v0
    v_lshlrev_b32 v19, 10, v19
    v_bfe_u32 v20, v0, 4, 1
    v_lshlrev_b32 v20, 2, v20
    v_and_b32 v21, 7, v0
    v_xor_b32 v21, v21, v20
    v_lshl_add_u32 v1, v21, 4, v19
    s_waitcnt lgkmcnt(0)
    s_mov_b32 s4, s20
    s_mov_b32 s5, s21
    s_mov_b32 s6, 1409024
    s_mov_b32 s7, 0x00020000
    s_mov_b32 s8, s24
    s_mov_b32 s9, s25
    s_mov_b32 s10, 33554432
    s_mov_b32 s11, 0x00020000
    s_mul_i32 s34, s28, 704512
    s_lshl_b32 s33, s27, 13
    s_add_u32 s34, s34, s33
    s_lshl_b32 s33, s30, 7
    s_add_u32 s34, s34, s33
    s_lshl_b32 s35, s27, 10
    s_lshl_b32 s33, s28, 11
    s_add_u32 s35, s35, s33
    s_lshl_b32 s32, s26, 10
    s_add_u32 s32, s32, 4096
    s_mul_i32 s36, s31, 88064
    s_mul_i32 s33, s28, 44032
    s_add_u32 s36, s36, s33
    s_add_u32 s36, s36, 11534336
    s_mov_b32 s33, 16384
    s_cmp_lt_u32 s47, 8
    s_cbranch_scc1 k5_kernel_31
    s_mov_b32 s35, s32
    s_mov_b32 s34, s36
    v_mov_b32 v1, v4
    s_mov_b32 s33, 1024
    s_mov_b32 s4, s8
    s_mov_b32 s5, s9
    s_mov_b32 s6, s10
    s_mov_b32 s7, s11
k5_kernel_31:
    s_sub_u32 s34, s34, s33
    s_cmp_lt_u32 s47, 8
    s_cbranch_scc1 k5_kernel_32
    s_cmp_lg_u32 s47, 8
    s_cbranch_scc1 k5_kernel_33
    s_lshr_b32 s38, s31, 2
    s_lshl_b32 s38, s38, 8
    s_add_u32 s38, s38, 17240064
    s_mov_b64 exec, 1
    s_mov_b32 s39, 0
    buffer_load_dword v32, off, s[8:11], s38 sc1
k5_kernel_34:
    s_waitcnt vmcnt(0)
    v_readfirstlane_b32 s37, v32
    s_cmp_ge_u32 s37, 15
    s_cbranch_scc1 k5_kernel_35
    buffer_load_dword v32, off, s[8:11], s38 sc1
    s_add_u32 s39, s39, 1
    s_cmp_lt_u32 s39, 0x8000
    s_cbranch_scc1 k5_kernel_34
k5_kernel_35:
    s_mov_b64 exec, -1
k5_kernel_33:
    s_barrier
    s_add_u32 m0, s35, 0
    s_add_u32 s34, s34, s33
    buffer_load_dwordx4 v1, s[4:7], s34 offen lds
    s_add_u32 m0, s35, 8192
    s_add_u32 s34, s34, s33
    buffer_load_dwordx4 v1, s[4:7], s34 offen lds
    s_add_u32 m0, s35, 16384
    s_add_u32 s34, s34, s33
    buffer_load_dwordx4 v1, s[4:7], s34 offen lds
    s_add_u32 m0, s35, 24576
    s_add_u32 s34, s34, s33
    buffer_load_dwordx4 v1, s[4:7], s34 offen lds
    s_add_u32 m0, s35, 32768
    s_add_u32 s34, s34, s33
    buffer_load_dwordx4 v1, s[4:7], s34 offen lds
    s_add_u32 m0, s35, 40960
    s_add_u32 s34, s34, s33
    buffer_load_dwordx4 v1, s[4:7], s34 offen lds
    s_add_u32 m0, s35, 49152
    s_add_u32 s34, s34, s33
    buffer_load_dwordx4 v1, s[4:7], s34 offen lds
    s_add_u32 m0, s35, 57344
    s_add_u32 s34, s34, s33
    buffer_load_dwordx4 v1, s[4:7], s34 offen lds
    s_waitcnt vmcnt(4)
    s_barrier
    s_add_u32 m0, s35, 65536
    s_add_u32 s34, s34, s33
    buffer_load_dwordx4 v1, s[4:7], s34 offen lds
    s_add_u32 m0, s35, 73728
    s_add_u32 s34, s34, s33
    buffer_load_dwordx4 v1, s[4:7], s34 offen lds
    s_add_u32 m0, s35, 81920
    s_add_u32 s34, s34, s33
    buffer_load_dwordx4 v1, s[4:7], s34 offen lds
    s_add_u32 m0, s35, 90112
    s_add_u32 s34, s34, s33
    buffer_load_dwordx4 v1, s[4:7], s34 offen lds
    s_waitcnt vmcnt(4)
    s_barrier
    s_add_u32 m0, s35, 98304
    s_add_u32 s34, s34, s33
    buffer_load_dwordx4 v1, s[4:7], s34 offen lds
    s_add_u32 m0, s35, 106496
    s_add_u32 s34, s34, s33
    buffer_load_dwordx4 v1, s[4:7], s34 offen lds
    s_add_u32 m0, s35, 114688
    s_add_u32 s34, s34, s33
    buffer_load_dwordx4 v1, s[4:7], s34 offen lds
    s_add_u32 m0, s35, 122880
    s_add_u32 s34, s34, s33
    buffer_load_dwordx4 v1, s[4:7], s34 offen lds
    s_add_u32 m0, s35, 0
    s_add_u32 s34, s34, s33
    buffer_load_dwordx4 v1, s[4:7], s34 offen lds
    s_add_u32 m0, s35, 8192
    s_add_u32 s34, s34, s33
    buffer_load_dwordx4 v1, s[4:7], s34 offen lds
    s_add_u32 m0, s35, 16384
    s_add_u32 s34, s34, s33
    buffer_load_dwordx4 v1, s[4:7], s34 offen lds
    s_add_u32 m0, s35, 24576
    s_add_u32 s34, s34, s33
    buffer_load_dwordx4 v1, s[4:7], s34 offen lds
    s_waitcnt vmcnt(8)
    s_barrier
    s_add_u32 m0, s35, 32768
    s_add_u32 s34, s34, s33
    buffer_load_dwordx4 v1, s[4:7], s34 offen lds
    s_add_u32 m0, s35, 40960
    s_add_u32 s34, s34, s33
    buffer_load_dwordx4 v1, s[4:7], s34 offen lds
    s_add_u32 m0, s35, 49152
    s_add_u32 s34, s34, s33
    buffer_load_dwordx4 v1, s[4:7], s34 offen lds
    s_add_u32 m0, s35, 57344
    s_add_u32 s34, s34, s33
    buffer_load_dwordx4 v1, s[4:7], s34 offen lds
    s_waitcnt vmcnt(8)
    s_barrier
    s_add_u32 m0, s35, 65536
    s_add_u32 s34, s34, s33
    buffer_load_dwordx4 v1, s[4:7], s34 offen lds
    s_add_u32 m0, s35, 73728
    s_add_u32 s34, s34, s33
    buffer_load_dwordx4 v1, s[4:7], s34 offen lds
    s_add_u32 m0, s35, 81920
    s_add_u32 s34, s34, s33
    buffer_load_dwordx4 v1, s[4:7], s34 offen lds
    s_add_u32 m0, s35, 90112
    s_add_u32 s34, s34, s33
    buffer_load_dwordx4 v1, s[4:7], s34 offen lds
    s_waitcnt vmcnt(8)
    s_barrier
    s_add_u32 m0, s35, 98304
    s_add_u32 s34, s34, s33
    buffer_load_dwordx4 v1, s[4:7], s34 offen lds
    s_add_u32 m0, s35, 106496
    s_add_u32 s34, s34, s33
    buffer_load_dwordx4 v1, s[4:7], s34 offen lds
    s_add_u32 m0, s35, 114688
    s_add_u32 s34, s34, s33
    buffer_load_dwordx4 v1, s[4:7], s34 offen lds
    s_add_u32 m0, s35, 122880
    s_add_u32 s34, s34, s33
    buffer_load_dwordx4 v1, s[4:7], s34 offen lds
    s_waitcnt vmcnt(8)
    s_barrier
    s_add_u32 m0, s35, 0
    s_add_u32 s34, s34, s33
    buffer_load_dwordx4 v1, s[4:7], s34 offen lds
    s_add_u32 m0, s35, 8192
    s_add_u32 s34, s34, s33
    buffer_load_dwordx4 v1, s[4:7], s34 offen lds
    s_add_u32 m0, s35, 16384
    s_add_u32 s34, s34, s33
    buffer_load_dwordx4 v1, s[4:7], s34 offen lds
    s_add_u32 m0, s35, 24576
    s_add_u32 s34, s34, s33
    buffer_load_dwordx4 v1, s[4:7], s34 offen lds
    s_waitcnt vmcnt(8)
    s_barrier
    s_add_u32 m0, s35, 32768
    s_add_u32 s34, s34, s33
    buffer_load_dwordx4 v1, s[4:7], s34 offen lds
    s_add_u32 m0, s35, 40960
    s_add_u32 s34, s34, s33
    buffer_load_dwordx4 v1, s[4:7], s34 offen lds
    s_add_u32 m0, s35, 49152
    s_add_u32 s34, s34, s33
    buffer_load_dwordx4 v1, s[4:7], s34 offen lds
    s_add_u32 m0, s35, 57344
    s_add_u32 s34, s34, s33
    buffer_load_dwordx4 v1, s[4:7], s34 offen lds
    s_waitcnt vmcnt(8)
    s_barrier
    s_add_u32 m0, s35, 65536
    s_add_u32 s34, s34, s33
    buffer_load_dwordx4 v1, s[4:7], s34 offen lds
    s_add_u32 m0, s35, 73728
    s_add_u32 s34, s34, s33
    buffer_load_dwordx4 v1, s[4:7], s34 offen lds
    s_add_u32 m0, s35, 81920
    s_add_u32 s34, s34, s33
    buffer_load_dwordx4 v1, s[4:7], s34 offen lds
    s_waitcnt vmcnt(7)
    s_barrier
    s_waitcnt vmcnt(3)
    s_barrier
    s_waitcnt vmcnt(0)
    s_barrier
    s_barrier
    s_endpgm
k5_kernel_32:
    s_add_u32 m0, s35, 0
    s_add_u32 s34, s34, s33
    buffer_load_dwordx4 v1, s[4:7], s34 offen lds
    s_add_u32 m0, s35, 8192
    s_add_u32 s34, s34, s33
    buffer_load_dwordx4 v1, s[4:7], s34 offen lds
    s_add_u32 m0, s35, 16384
    s_add_u32 s34, s34, s33
    buffer_load_dwordx4 v1, s[4:7], s34 offen lds
    s_add_u32 m0, s35, 24576
    s_add_u32 s34, s34, s33
    buffer_load_dwordx4 v1, s[4:7], s34 offen lds
    s_add_u32 m0, s35, 32768
    s_add_u32 s34, s34, s33
    buffer_load_dwordx4 v1, s[4:7], s34 offen lds
    s_add_u32 m0, s35, 40960
    s_add_u32 s34, s34, s33
    buffer_load_dwordx4 v1, s[4:7], s34 offen lds
    s_add_u32 m0, s35, 49152
    s_add_u32 s34, s34, s33
    buffer_load_dwordx4 v1, s[4:7], s34 offen lds
    s_add_u32 m0, s35, 57344
    s_add_u32 s34, s34, s33
    buffer_load_dwordx4 v1, s[4:7], s34 offen lds
    s_add_u32 m0, s35, 65536
    s_add_u32 s34, s34, s33
    buffer_load_dwordx4 v1, s[4:7], s34 offen lds
    s_add_u32 m0, s35, 73728
    s_add_u32 s34, s34, s33
    buffer_load_dwordx4 v1, s[4:7], s34 offen lds
    s_add_u32 m0, s35, 81920
    s_add_u32 s34, s34, s33
    buffer_load_dwordx4 v1, s[4:7], s34 offen lds
    s_add_u32 m0, s35, 90112
    s_add_u32 s34, s34, s33
    buffer_load_dwordx4 v1, s[4:7], s34 offen lds
    s_add_u32 m0, s35, 98304
    s_add_u32 s34, s34, s33
    buffer_load_dwordx4 v1, s[4:7], s34 offen lds
    s_add_u32 m0, s35, 106496
    s_add_u32 s34, s34, s33
    buffer_load_dwordx4 v1, s[4:7], s34 offen lds
    s_add_u32 m0, s35, 114688
    s_add_u32 s34, s34, s33
    buffer_load_dwordx4 v1, s[4:7], s34 offen lds
    s_add_u32 m0, s35, 122880
    s_add_u32 s34, s34, s33
    buffer_load_dwordx4 v1, s[4:7], s34 offen lds
    s_barrier
    s_waitcnt vmcnt(12)
    s_barrier
    s_waitcnt vmcnt(8)
    s_barrier
    s_add_u32 m0, s35, 0
    s_add_u32 s34, s34, s33
    buffer_load_dwordx4 v1, s[4:7], s34 offen lds
    s_add_u32 m0, s35, 8192
    s_add_u32 s34, s34, s33
    buffer_load_dwordx4 v1, s[4:7], s34 offen lds
    s_add_u32 m0, s35, 16384
    s_add_u32 s34, s34, s33
    buffer_load_dwordx4 v1, s[4:7], s34 offen lds
    s_add_u32 m0, s35, 24576
    s_add_u32 s34, s34, s33
    buffer_load_dwordx4 v1, s[4:7], s34 offen lds
    s_waitcnt vmcnt(8)
    s_barrier
    s_add_u32 m0, s35, 32768
    s_add_u32 s34, s34, s33
    buffer_load_dwordx4 v1, s[4:7], s34 offen lds
    s_add_u32 m0, s35, 40960
    s_add_u32 s34, s34, s33
    buffer_load_dwordx4 v1, s[4:7], s34 offen lds
    s_add_u32 m0, s35, 49152
    s_add_u32 s34, s34, s33
    buffer_load_dwordx4 v1, s[4:7], s34 offen lds
    s_add_u32 m0, s35, 57344
    s_add_u32 s34, s34, s33
    buffer_load_dwordx4 v1, s[4:7], s34 offen lds
    s_waitcnt vmcnt(8)
    s_barrier
    s_add_u32 m0, s35, 65536
    s_add_u32 s34, s34, s33
    buffer_load_dwordx4 v1, s[4:7], s34 offen lds
    s_add_u32 m0, s35, 73728
    s_add_u32 s34, s34, s33
    buffer_load_dwordx4 v1, s[4:7], s34 offen lds
    s_add_u32 m0, s35, 81920
    s_add_u32 s34, s34, s33
    buffer_load_dwordx4 v1, s[4:7], s34 offen lds
    s_add_u32 m0, s35, 90112
    s_add_u32 s34, s34, s33
    buffer_load_dwordx4 v1, s[4:7], s34 offen lds
    s_waitcnt vmcnt(8)
    s_barrier
    s_add_u32 m0, s35, 98304
    s_add_u32 s34, s34, s33
    buffer_load_dwordx4 v1, s[4:7], s34 offen lds
    s_add_u32 m0, s35, 106496
    s_add_u32 s34, s34, s33
    buffer_load_dwordx4 v1, s[4:7], s34 offen lds
    s_add_u32 m0, s35, 114688
    s_add_u32 s34, s34, s33
    buffer_load_dwordx4 v1, s[4:7], s34 offen lds
    s_add_u32 m0, s35, 122880
    s_add_u32 s34, s34, s33
    buffer_load_dwordx4 v1, s[4:7], s34 offen lds
    s_waitcnt vmcnt(8)
    s_barrier
    s_add_u32 m0, s35, 0
    s_add_u32 s34, s34, s33
    buffer_load_dwordx4 v1, s[4:7], s34 offen lds
    s_add_u32 m0, s35, 8192
    s_add_u32 s34, s34, s33
    buffer_load_dwordx4 v1, s[4:7], s34 offen lds
    s_add_u32 m0, s35, 16384
    s_add_u32 s34, s34, s33
    buffer_load_dwordx4 v1, s[4:7], s34 offen lds
    s_add_u32 m0, s35, 24576
    s_add_u32 s34, s34, s33
    buffer_load_dwordx4 v1, s[4:7], s34 offen lds
    s_waitcnt vmcnt(8)
    s_barrier
    s_add_u32 m0, s35, 32768
    s_add_u32 s34, s34, s33
    buffer_load_dwordx4 v1, s[4:7], s34 offen lds
    s_add_u32 m0, s35, 40960
    s_add_u32 s34, s34, s33
    buffer_load_dwordx4 v1, s[4:7], s34 offen lds
    s_add_u32 m0, s35, 49152
    s_add_u32 s34, s34, s33
    buffer_load_dwordx4 v1, s[4:7], s34 offen lds
    s_add_u32 m0, s35, 57344
    s_add_u32 s34, s34, s33
    buffer_load_dwordx4 v1, s[4:7], s34 offen lds
    s_waitcnt vmcnt(8)
    s_barrier
    s_add_u32 m0, s35, 65536
    s_add_u32 s34, s34, s33
    buffer_load_dwordx4 v1, s[4:7], s34 offen lds
    s_add_u32 m0, s35, 73728
    s_add_u32 s34, s34, s33
    buffer_load_dwordx4 v1, s[4:7], s34 offen lds
    s_add_u32 m0, s35, 81920
    s_add_u32 s34, s34, s33
    buffer_load_dwordx4 v1, s[4:7], s34 offen lds
    s_waitcnt vmcnt(7)
    s_barrier
    s_waitcnt vmcnt(3)
    s_barrier
    s_waitcnt vmcnt(0)
    s_barrier
    s_barrier
    s_endpgm
k5_kernel_exit:
    s_endpgm
.section .rodata,"a"
.p2align 6
.amdhsa_kernel k1_kernel
  .amdhsa_next_free_vgpr 168
  .amdhsa_next_free_sgpr 64
  .amdhsa_accum_offset 168
  .amdhsa_group_segment_fixed_size 0
  .amdhsa_kernarg_size 80
  .amdhsa_user_sgpr_count 2
  .amdhsa_user_sgpr_kernarg_segment_ptr 1
  .amdhsa_system_sgpr_workgroup_id_x 1
.end_amdhsa_kernel
.p2align 6
.amdhsa_kernel k2_kernel
  .amdhsa_next_free_vgpr 128
  .amdhsa_next_free_sgpr 64
  .amdhsa_accum_offset 128
  .amdhsa_group_segment_fixed_size 0
  .amdhsa_kernarg_size 80
  .amdhsa_user_sgpr_count 2
  .amdhsa_user_sgpr_kernarg_segment_ptr 1
  .amdhsa_system_sgpr_workgroup_id_x 1
.end_amdhsa_kernel
.p2align 6
.amdhsa_kernel k3_kernel
  .amdhsa_next_free_vgpr 168
  .amdhsa_next_free_sgpr 64
  .amdhsa_accum_offset 168
  .amdhsa_group_segment_fixed_size 0
  .amdhsa_kernarg_size 80
  .amdhsa_user_sgpr_count 2
  .amdhsa_user_sgpr_kernarg_segment_ptr 1
  .amdhsa_system_sgpr_workgroup_id_x 1
.end_amdhsa_kernel
```
